```python
import torch

def _softmax(x, axis=-1):
    return torch.softmax(x, dim=axis)
def _gelu(x):
    return torch.nn.functional.gelu(x, approximate="tanh")
def _silu(x):
    return torch.nn.functional.silu(x)
def _sigmoid(x):
    return torch.sigmoid(x)
def _layernorm(x, axis=-1, eps=1e-5):
    m = x.mean(dim=axis, keepdim=True)
    v = x.var(dim=axis, keepdim=True, unbiased=False)
    return (x - m) / torch.sqrt(v + eps)
def _scatter_add(tgt, idx, src, axis=0):
    return tgt.clone().index_add_(axis, idx, src)
def _segment_sum(src, seg, n):
    out = torch.zeros((n,) + src.shape[1:], dtype=src.dtype)
    return out.index_add_(0, seg, src)
def _pad(x, pw):
    flat = tuple(v for pair in reversed(pw) for v in pair)
    return torch.nn.functional.pad(x, flat)

kernel_name = 'sequential_preLN__sliding_local_dilated__dense_activation_silu__prompt'

def setup_inputs():

    _w = (lambda a: (lambda t: t.to(torch.bfloat16) if t.is_floating_point() else t)(torch.as_tensor(a)))
    def _A_setup():
        B, S, D = 1, 2048, 512
        return {
            "x": _w((lambda *s: torch.randn(*s, dtype=torch.bfloat16) * 0.05)(B, S, D)),
            "wqkv": _w((lambda *s: torch.randn(*s, dtype=torch.bfloat16) * 0.05)(D, 3 * D)),
            "wo": _w((lambda *s: torch.randn(*s, dtype=torch.bfloat16) * 0.05)(D, D)),
        }
    _A_in = _A_setup()

    def _B_setup():
        B, S, D, F = 1, 2048, 512, 1376
        return {
            "x": _w((lambda *s: torch.randn(*s, dtype=torch.bfloat16) * 0.05)(B, S, D)),
            "w1": _w((lambda *s: torch.randn(*s, dtype=torch.bfloat16) * 0.8)(D, F) * (D ** -0.5)),
            "w2": _w((lambda *s: torch.randn(*s, dtype=torch.bfloat16) * 0.8)(F, D) * (F ** -0.5)),
        }
    _B_in = _B_setup()

    return {
        "A_x": _A_in["x"],
        "A_wqkv": _A_in["wqkv"],
        "A_wo": _A_in["wo"],
        "B_x": _B_in["x"],
        "B_w1": _B_in["w1"],
        "B_w2": _B_in["w2"],
    }

def reference(A_x, A_wqkv, A_wo, B_x, B_w1, B_w2):
    def _A_ref(x, wqkv, wo):
        B, S, D = x.shape
        H = 32; Dh = D // H
        W, dil = 8, 2
        qkv = (lambda x, *d: x.permute(*d))((x @ wqkv).reshape(B, S, 3, H, Dh), 2, 0, 3, 1, 4)
        q, k, v = qkv[0], qkv[1], qkv[2]
        scale = Dh ** -0.5
        pos = torch.arange(S)
        off = torch.arange(W) * dil
        idx = pos[:, None] - off[None, :]
        mask = idx >= 0
        idx_c = torch.where(mask, idx, 0).reshape(-1)
        kg = k[:, :, idx_c, :].reshape(B, H, S, W, Dh)
        vg = v[:, :, idx_c, :].reshape(B, H, S, W, Dh)
        logits = torch.einsum("bhsd,bhswd->bhsw", q, kg) * scale
        logits = torch.where(mask[None, None, :, :], logits, -1e9)
        attn = _softmax(logits, axis=-1)
        o = torch.einsum("bhsw,bhswd->bhsd", attn, vg)
        return (lambda x, *d: x.permute(*d))(o, 0, 2, 1, 3).reshape(B, S, D) @ wo

    def _B_ref(x, w1, w2):
        h = torch.einsum("bsd,df->bsf", x, w1)
        h = _silu(h)
        out = torch.einsum("bsf,fd->bsd", h, w2)
        return out

    x = A_x
    h = x + _A_ref(_layernorm(x, axis=-1), A_wqkv, A_wo)
    h2 = h + _B_ref(_layernorm(h, axis=-1), B_w1, B_w2)
    return h2
```

```asm
; @launch grid=(256,1,1) block=(512,1,1) lds=163840
.amdgcn_target "amdgcn-amd-amdhsa--gfx950"
.text
.globl sequential_preLN__sliding_local_dilated__dense_activation_silu__prompt_kernel
.p2align 8
.type sequential_preLN__sliding_local_dilated__dense_activation_silu__prompt_kernel,@function
sequential_preLN__sliding_local_dilated__dense_activation_silu__prompt_kernel:
    s_lshr_b32 s3, s2, 8
    s_cbranch_scc1 L_end
    s_load_dwordx2 s[8:9], s[0:1], 8
    s_load_dwordx2 s[4:5], s[0:1], 0
    v_lshrrev_b32 v4, 6, v0
    v_and_b32 v1, 63, v0
    s_and_b32 s42, s2, 7
    v_readfirstlane_b32 s36, v4
    s_lshr_b32 s41, s2, 3
    s_and_b32 s35, s41, 7
    s_andn2_b32 s41, s41, 7
    s_or_b32 s34, s41, s42
    s_cmp_eq_u32 s42, 7
    s_cselect_b32 s37, 3, s42
    s_cmp_lt_u32 s36, 4
    s_cbranch_scc1 L_compute
    s_sub_u32 s71, s36, 4
    v_lshrrev_b32 v3, 4, v1
    v_lshrrev_b32 v22, 3, v1
    v_and_b32 v7, 7, v1
    s_lshl_b32 s42, s71, 3
    v_add_u32 v23, s42, v22
    s_and_b32 s42, s71, 1
    s_lshl_b32 s42, s42, 1
    v_mul_u32_u24 v5, 3072, v23
    v_and_b32 v6, 1, v3
    v_add_u32 v6, s42, v6
    v_lshlrev_b32 v6, 5, v6
    v_lshlrev_b32 v24, 4, v7
    v_xor_b32 v6, v24, v6
    s_lshl_b32 s43, s35, 7
    v_add3_u32 v10, v5, v6, s43
    s_mul_i32 s54, s71, 3
    s_addk_i32 s54, 80
    s_lshl_b32 s54, s54, 10
    s_mov_b32 s11, 0x20000
    s_mov_b32 s10, 1572864
    s_cmp_ge_u32 s37, 3
    s_addc_u32 s44, s37, 0
    s_mul_i32 s46, s44, 196608
    s_add_u32 m0, s54, 0
    s_waitcnt lgkmcnt(0)
    buffer_load_dwordx4 v10, s[8:11], s46 offen offset:0 lds
    buffer_load_dwordx4 v10, s[8:11], s46 offen offset:1024 lds
    buffer_load_dwordx4 v10, s[8:11], s46 offen offset:2048 lds
    s_mov_b32 s7, 0x20000
    s_mov_b32 s6, 2097152
    s_lshl_b32 s41, s34, 6
    s_lshl_b32 s42, s71, 4
    s_add_u32 s42, s42, s41
    v_add_u32 v5, s42, v22
    v_lshlrev_b32 v5, 10, v5
    v_xor_b32 v6, v7, v3
    v_lshlrev_b32 v6, 4, v6
    v_add_u32 v8, v5, v6
    s_add_u32 s55, s71, 1
    s_lshl_b32 s55, s55, 14
    s_lshl_b32 s45, s44, 7
    s_mov_b32 m0, s55
    v_xor_b32 v9, 64, v8
    buffer_load_dwordx4 v8, s[4:7], s45 offen lds
    v_add_u32 v9, 0x2000, v9
    s_addk_i32 m0, 1024
    s_nop 0
    buffer_load_dwordx4 v9, s[4:7], s45 offen lds
    s_cmp_lt_u32 s71, 2
    s_cselect_b64 vcc, -1, 0
    v_cndmask_b32 v15, v9, v8, vcc
    v_subrev_u32 v15, s55, v15
    s_lshr_b32 s56, s71, 1
    s_lshl_b32 s56, s56, 10
    s_bitcmp1_b32 s71, 0
    s_cselect_b32 s58, 0, -1
    s_cselect_b32 s59, -1, 0
    s_cmp_eq_u32 s71, 0
    s_cselect_b32 s42, 0xff, 0
    s_andn2_b32 s58, s58, s42
    s_mov_b32 m0, s56
    s_mov_b64 exec, s[58:59]
    buffer_load_dwordx4 v15, s[4:7], s45 offen lds
    s_mov_b64 exec, -1
    s_getpc_b64 s[90:91]
L_pfbase:
    s_lshr_b32 s41, s2, 3
    s_lshl_b32 s41, s41, 2
    s_add_u32 s41, s41, s71
    s_lshl_b32 s41, s41, 9
    v_and_b32 v4, 3, v1
    v_lshlrev_b32 v4, 7, v4
    v_add_u32 v4, s41, v4
    s_mov_b32 s92, (L_code_end-L_pfbase-4)
    v_min_u32 v5, s92, v4
    s_mov_b64 exec, 0xf
    global_load_dword v30, v5, s[90:91]
    s_mov_b64 exec, -1
    s_load_dwordx16 s[72:87], s[0:1], 0
    s_load_dwordx2 s[88:89], s[0:1], 64
    s_mul_i32 s47, s35, 43
    s_lshr_b32 s47, s47, 3
    s_mul_i32 s70, s35, 11
    s_lshr_b32 s70, s70, 2
    s_lshl_b32 s41, s34, 9
    s_lshl_b32 s42, s35, 2
    s_add_u32 s42, s42, s71
    s_mul_i32 s42, s42, 20
    s_add_u32 s41, s41, s42
    s_sub_u32 s41, s41, 128
    v_add_u32 v5, s41, v1
    v_and_b32 v6, 7, v5
    v_cmp_eq_u32 vcc, 3, v6
    v_lshlrev_b32 v5, 7, v5
    s_nop 0
    v_cndmask_b32 v5, v5, -1, vcc
    s_bfm_b64 exec, 20, 0
    buffer_load_dword v36, v5, s[4:7], 0 offen
    s_mov_b64 exec, -1
    s_cmp_ge_u32 s37, 3
    s_addc_u32 s44, s37, 0
    s_mul_i32 s46, s44, 196608
    s_add_u32 s46, s46, 98304
    s_add_u32 m0, s54, 12288
    s_nop 0
    buffer_load_dwordx4 v10, s[8:11], s46 offen offset:0 lds
    buffer_load_dwordx4 v10, s[8:11], s46 offen offset:1024 lds
    buffer_load_dwordx4 v10, s[8:11], s46 offen offset:2048 lds
    s_add_u32 s44, s37, 1
    s_cmp_ge_u32 s44, 7
    s_cselect_b32 s43, 7, 0
    s_sub_u32 s44, s44, s43
    s_cmp_ge_u32 s44, 3
    s_addc_u32 s44, s44, 0
    s_lshl_b32 s45, s44, 7
    s_add_u32 m0, s55, 2048
    s_nop 0
    buffer_load_dwordx4 v8, s[4:7], s45 offen lds
    s_add_u32 m0, s55, 3072
    s_nop 0
    buffer_load_dwordx4 v9, s[4:7], s45 offen lds
    s_add_u32 m0, s56, 2048
    s_mov_b64 exec, s[58:59]
    buffer_load_dwordx4 v15, s[4:7], s45 offen lds
    s_mov_b64 exec, -1
    s_add_u32 s44, s37, 1
    s_cmp_ge_u32 s44, 7
    s_cselect_b32 s43, 7, 0
    s_sub_u32 s44, s44, s43
    s_cmp_ge_u32 s44, 3
    s_addc_u32 s44, s44, 0
    s_mul_i32 s46, s44, 196608
    s_add_u32 m0, s54, 24576
    s_nop 0
    buffer_load_dwordx4 v10, s[8:11], s46 offen offset:0 lds
    buffer_load_dwordx4 v10, s[8:11], s46 offen offset:1024 lds
    buffer_load_dwordx4 v10, s[8:11], s46 offen offset:2048 lds
    s_add_u32 s44, s37, 1
    s_cmp_ge_u32 s44, 7
    s_cselect_b32 s43, 7, 0
    s_sub_u32 s44, s44, s43
    s_cmp_ge_u32 s44, 3
    s_addc_u32 s44, s44, 0
    s_mul_i32 s46, s44, 196608
    s_add_u32 s46, s46, 98304
    s_add_u32 m0, s54, 36864
    s_nop 0
    buffer_load_dwordx4 v10, s[8:11], s46 offen offset:0 lds
    buffer_load_dwordx4 v10, s[8:11], s46 offen offset:1024 lds
    buffer_load_dwordx4 v10, s[8:11], s46 offen offset:2048 lds
    s_waitcnt vmcnt(13)
    s_barrier
    s_waitcnt vmcnt(9)
    s_barrier
    s_add_u32 s44, s37, 2
    s_cmp_ge_u32 s44, 7
    s_cselect_b32 s43, 7, 0
    s_sub_u32 s44, s44, s43
    s_cmp_ge_u32 s44, 3
    s_addc_u32 s44, s44, 0
    s_lshl_b32 s45, s44, 7
    s_add_u32 m0, s55, 4096
    s_nop 0
    buffer_load_dwordx4 v8, s[4:7], s45 offen lds
    s_add_u32 m0, s55, 5120
    s_nop 0
    buffer_load_dwordx4 v9, s[4:7], s45 offen lds
    s_add_u32 m0, s56, 4096
    s_mov_b64 exec, s[58:59]
    buffer_load_dwordx4 v15, s[4:7], s45 offen lds
    s_mov_b64 exec, -1
    s_add_u32 s44, s37, 2
    s_cmp_ge_u32 s44, 7
    s_cselect_b32 s43, 7, 0
    s_sub_u32 s44, s44, s43
    s_cmp_ge_u32 s44, 3
    s_addc_u32 s44, s44, 0
    s_mul_i32 s46, s44, 196608
    s_add_u32 m0, s54, 49152
    s_nop 0
    buffer_load_dwordx4 v10, s[8:11], s46 offen offset:0 lds
    buffer_load_dwordx4 v10, s[8:11], s46 offen offset:1024 lds
    buffer_load_dwordx4 v10, s[8:11], s46 offen offset:2048 lds
    s_add_u32 s44, s37, 2
    s_cmp_ge_u32 s44, 7
    s_cselect_b32 s43, 7, 0
    s_sub_u32 s44, s44, s43
    s_cmp_ge_u32 s44, 3
    s_addc_u32 s44, s44, 0
    s_mul_i32 s46, s44, 196608
    s_add_u32 s46, s46, 98304
    s_add_u32 m0, s54, 61440
    s_nop 0
    buffer_load_dwordx4 v10, s[8:11], s46 offen offset:0 lds
    buffer_load_dwordx4 v10, s[8:11], s46 offen offset:1024 lds
    buffer_load_dwordx4 v10, s[8:11], s46 offen offset:2048 lds
    s_waitcnt vmcnt(12)
    s_barrier
    s_add_u32 s44, s37, 3
    s_cmp_ge_u32 s44, 7
    s_cselect_b32 s43, 7, 0
    s_sub_u32 s44, s44, s43
    s_cmp_ge_u32 s44, 3
    s_addc_u32 s44, s44, 0
    s_lshl_b32 s45, s44, 7
    s_add_u32 m0, s55, 6144
    s_nop 0
    buffer_load_dwordx4 v8, s[4:7], s45 offen lds
    s_add_u32 m0, s55, 7168
    s_nop 0
    buffer_load_dwordx4 v9, s[4:7], s45 offen lds
    s_add_u32 m0, s56, 6144
    s_mov_b64 exec, s[58:59]
    buffer_load_dwordx4 v15, s[4:7], s45 offen lds
    s_mov_b64 exec, -1
    s_add_u32 s44, s37, 3
    s_cmp_ge_u32 s44, 7
    s_cselect_b32 s43, 7, 0
    s_sub_u32 s44, s44, s43
    s_cmp_ge_u32 s44, 3
    s_addc_u32 s44, s44, 0
    s_mul_i32 s46, s44, 196608
    s_add_u32 m0, s54, 0
    s_nop 0
    buffer_load_dwordx4 v10, s[8:11], s46 offen offset:0 lds
    buffer_load_dwordx4 v10, s[8:11], s46 offen offset:1024 lds
    buffer_load_dwordx4 v10, s[8:11], s46 offen offset:2048 lds
    s_waitcnt vmcnt(15)
    s_barrier
    s_add_u32 s44, s37, 3
    s_cmp_ge_u32 s44, 7
    s_cselect_b32 s43, 7, 0
    s_sub_u32 s44, s44, s43
    s_cmp_ge_u32 s44, 3
    s_addc_u32 s44, s44, 0
    s_mul_i32 s46, s44, 196608
    s_add_u32 s46, s46, 98304
    s_add_u32 m0, s54, 12288
    s_nop 0
    buffer_load_dwordx4 v10, s[8:11], s46 offen offset:0 lds
    buffer_load_dwordx4 v10, s[8:11], s46 offen offset:1024 lds
    buffer_load_dwordx4 v10, s[8:11], s46 offen offset:2048 lds
    s_waitcnt lgkmcnt(0)
    v_lshlrev_b32 v5, 10, v23
    v_lshlrev_b32 v6, 1, v3
    v_and_b32 v7, 7, v1
    v_xor_b32 v6, v7, v6
    v_lshlrev_b32 v6, 4, v6
    s_lshl_b32 s43, s35, 7
    v_add3_u32 v11, v5, v6, s43
    s_lshl_b32 s57, s71, 10
    s_lshl_b32 s61, s35, 1
    s_mov_b32 s12, s76
    s_and_b32 s13, s77, 0xffff
    s_mov_b32 s14, 524288
    s_mov_b32 s15, 0x20000
    s_mov_b32 s16, s80
    s_and_b32 s17, s81, 0xffff
    s_mov_b32 s18, 1409024
    s_mov_b32 s19, 0x20000
    s_waitcnt vmcnt(12)
    s_barrier
    s_add_u32 s44, s37, 4
    s_cmp_ge_u32 s44, 7
    s_cselect_b32 s43, 7, 0
    s_sub_u32 s44, s44, s43
    s_cmp_ge_u32 s44, 3
    s_addc_u32 s44, s44, 0
    s_lshl_b32 s45, s44, 7
    s_add_u32 m0, s55, 8192
    s_nop 0
    buffer_load_dwordx4 v8, s[4:7], s45 offen lds
    s_add_u32 m0, s55, 9216
    s_nop 0
    buffer_load_dwordx4 v9, s[4:7], s45 offen lds
    s_add_u32 m0, s56, 8192
    s_mov_b64 exec, s[58:59]
    buffer_load_dwordx4 v15, s[4:7], s45 offen lds
    s_mov_b64 exec, -1
    s_add_u32 s44, s37, 4
    s_cmp_ge_u32 s44, 7
    s_cselect_b32 s43, 7, 0
    s_sub_u32 s44, s44, s43
    s_cmp_ge_u32 s44, 3
    s_addc_u32 s44, s44, 0
    s_mul_i32 s46, s44, 196608
    s_add_u32 m0, s54, 24576
    s_nop 0
    buffer_load_dwordx4 v10, s[8:11], s46 offen offset:0 lds
    buffer_load_dwordx4 v10, s[8:11], s46 offen offset:1024 lds
    buffer_load_dwordx4 v10, s[8:11], s46 offen offset:2048 lds
    s_mov_b32 s41, 43691
    v_add_u32 v4, 0, v1
    v_mul_u32_u24 v5, s41, v4
    v_lshrrev_b32 v5, 20, v5
    v_mul_u32_u24 v6, 24, v5
    v_sub_u32 v6, v4, v6
    v_lshrrev_b32 v7, 1, v5
    v_and_b32 v7, 3, v7
    v_lshlrev_b32 v7, 1, v7
    v_xor_b32 v6, v6, v7
    v_lshlrev_b32 v6, 4, v6
    s_lshl_b32 s42, s71, 3
    v_add_u32 v5, s42, v5
    v_mul_u32_u24 v5, 2752, v5
    s_lshl_b32 s42, s47, 6
    v_add3_u32 v12, v5, v6, s42
    s_waitcnt vmcnt(15)
    s_barrier
    s_add_u32 s44, s37, 4
    s_cmp_ge_u32 s44, 7
    s_cselect_b32 s43, 7, 0
    s_sub_u32 s44, s44, s43
    s_cmp_ge_u32 s44, 3
    s_addc_u32 s44, s44, 0
    s_mul_i32 s46, s44, 196608
    s_add_u32 s46, s46, 98304
    s_add_u32 m0, s54, 36864
    s_nop 0
    buffer_load_dwordx4 v10, s[8:11], s46 offen offset:0 lds
    buffer_load_dwordx4 v10, s[8:11], s46 offen offset:1024 lds
    buffer_load_dwordx4 v10, s[8:11], s46 offen offset:2048 lds
    s_mov_b32 s41, 43691
    v_add_u32 v4, 64, v1
    v_mul_u32_u24 v5, s41, v4
    v_lshrrev_b32 v5, 20, v5
    v_mul_u32_u24 v6, 24, v5
    v_sub_u32 v6, v4, v6
    v_lshrrev_b32 v7, 1, v5
    v_and_b32 v7, 3, v7
    v_lshlrev_b32 v7, 1, v7
    v_xor_b32 v6, v6, v7
    v_lshlrev_b32 v6, 4, v6
    s_lshl_b32 s42, s71, 3
    v_add_u32 v5, s42, v5
    v_mul_u32_u24 v5, 2752, v5
    s_lshl_b32 s42, s47, 6
    v_add3_u32 v13, v5, v6, s42
    v_subrev_u32 v13, 1024, v13
    s_waitcnt vmcnt(12)
    s_barrier
    s_add_u32 s44, s37, 5
    s_cmp_ge_u32 s44, 7
    s_cselect_b32 s43, 7, 0
    s_sub_u32 s44, s44, s43
    s_cmp_ge_u32 s44, 3
    s_addc_u32 s44, s44, 0
    s_lshl_b32 s45, s44, 7
    s_add_u32 m0, s55, 10240
    s_nop 0
    buffer_load_dwordx4 v8, s[4:7], s45 offen lds
    s_add_u32 m0, s55, 11264
    s_nop 0
    buffer_load_dwordx4 v9, s[4:7], s45 offen lds
    s_add_u32 m0, s56, 10240
    s_mov_b64 exec, s[58:59]
    buffer_load_dwordx4 v15, s[4:7], s45 offen lds
    s_mov_b64 exec, -1
    s_add_u32 s44, s37, 5
    s_cmp_ge_u32 s44, 7
    s_cselect_b32 s43, 7, 0
    s_sub_u32 s44, s44, s43
    s_cmp_ge_u32 s44, 3
    s_addc_u32 s44, s44, 0
    s_mul_i32 s46, s44, 196608
    s_add_u32 m0, s54, 49152
    s_nop 0
    buffer_load_dwordx4 v10, s[8:11], s46 offen offset:0 lds
    buffer_load_dwordx4 v10, s[8:11], s46 offen offset:1024 lds
    buffer_load_dwordx4 v10, s[8:11], s46 offen offset:2048 lds
    s_mov_b32 s41, 43691
    v_add_u32 v4, 128, v1
    v_mul_u32_u24 v5, s41, v4
    v_lshrrev_b32 v5, 20, v5
    v_mul_u32_u24 v6, 24, v5
    v_sub_u32 v6, v4, v6
    v_lshrrev_b32 v7, 1, v5
    v_and_b32 v7, 3, v7
    v_lshlrev_b32 v7, 1, v7
    v_xor_b32 v6, v6, v7
    v_lshlrev_b32 v6, 4, v6
    s_lshl_b32 s42, s71, 3
    v_add_u32 v5, s42, v5
    v_mul_u32_u24 v5, 2752, v5
    s_lshl_b32 s42, s47, 6
    v_add3_u32 v14, v5, v6, s42
    v_subrev_u32 v14, 2048, v14
    s_waitcnt vmcnt(15)
    s_barrier
    s_add_u32 s44, s37, 5
    s_cmp_ge_u32 s44, 7
    s_cselect_b32 s43, 7, 0
    s_sub_u32 s44, s44, s43
    s_cmp_ge_u32 s44, 3
    s_addc_u32 s44, s44, 0
    s_mul_i32 s46, s44, 196608
    s_add_u32 s46, s46, 98304
    s_add_u32 m0, s54, 61440
    s_nop 0
    buffer_load_dwordx4 v10, s[8:11], s46 offen offset:0 lds
    buffer_load_dwordx4 v10, s[8:11], s46 offen offset:1024 lds
    buffer_load_dwordx4 v10, s[8:11], s46 offen offset:2048 lds
    s_mov_b32 s20, s82
    s_and_b32 s21, s83, 0xffff
    s_mov_b32 s22, 1409024
    s_mov_b32 s23, 0x20000
    s_mov_b32 s28, s88
    s_and_b32 s29, s89, 0xffff
    s_mov_b32 s30, 16777216
    s_mov_b32 s31, 0x20000
    v_lshlrev_b32 v16, 4, v1
    v_add_u32 v18, s57, v16
    v_add_u32 v19, 0x10000, v18
    v_add_u32 v20, 0x20000, v18
    s_waitcnt vmcnt(12)
    s_barrier
    s_add_u32 s44, s37, 6
    s_cmp_ge_u32 s44, 7
    s_cselect_b32 s43, 7, 0
    s_sub_u32 s44, s44, s43
    s_cmp_ge_u32 s44, 3
    s_addc_u32 s44, s44, 0
    s_lshl_b32 s45, s44, 7
    s_add_u32 m0, s55, 12288
    s_nop 0
    buffer_load_dwordx4 v8, s[4:7], s45 offen lds
    s_add_u32 m0, s55, 13312
    s_nop 0
    buffer_load_dwordx4 v9, s[4:7], s45 offen lds
    s_add_u32 m0, s56, 12288
    s_mov_b64 exec, s[58:59]
    buffer_load_dwordx4 v15, s[4:7], s45 offen lds
    s_mov_b64 exec, -1
    s_add_u32 s44, s37, 6
    s_cmp_ge_u32 s44, 7
    s_cselect_b32 s43, 7, 0
    s_sub_u32 s44, s44, s43
    s_cmp_ge_u32 s44, 3
    s_addc_u32 s44, s44, 0
    s_mul_i32 s46, s44, 196608
    s_add_u32 m0, s54, 0
    s_nop 0
    buffer_load_dwordx4 v10, s[8:11], s46 offen offset:0 lds
    buffer_load_dwordx4 v10, s[8:11], s46 offen offset:1024 lds
    buffer_load_dwordx4 v10, s[8:11], s46 offen offset:2048 lds
    s_lshl_b32 s41, s34, 7
    s_add_u32 s41, s41, 11534336
    v_and_b32 v4, 31, v1
    v_lshlrev_b32 v4, 2, v4
    v_add_u32 v17, s41, v4
    s_lshl_b32 s41, s34, 2
    s_add_u32 s41, s41, s71
    s_lshl_b32 s60, s41, 14
    s_add_u32 s60, s60, 2097152
    s_lshl_b32 s62, s41, 10
    s_add_u32 s62, s62, 10485760
    s_waitcnt vmcnt(15)
    s_barrier
    s_add_u32 s44, s37, 6
    s_cmp_ge_u32 s44, 7
    s_cselect_b32 s43, 7, 0
    s_sub_u32 s44, s44, s43
    s_cmp_ge_u32 s44, 3
    s_addc_u32 s44, s44, 0
    s_mul_i32 s46, s44, 196608
    s_add_u32 s46, s46, 98304
    s_add_u32 m0, s54, 12288
    s_nop 0
    buffer_load_dwordx4 v10, s[8:11], s46 offen offset:0 lds
    buffer_load_dwordx4 v10, s[8:11], s46 offen offset:1024 lds
    buffer_load_dwordx4 v10, s[8:11], s46 offen offset:2048 lds
    s_waitcnt vmcnt(12)
    s_barrier
    s_mov_b32 s44, 3
    s_lshl_b32 s45, s44, 7
    s_add_u32 m0, s55, 14336
    s_nop 0
    buffer_load_dwordx4 v8, s[4:7], s45 offen lds
    s_add_u32 m0, s55, 15360
    s_nop 0
    buffer_load_dwordx4 v9, s[4:7], s45 offen lds
    s_add_u32 m0, s56, 14336
    s_mov_b64 exec, s[58:59]
    buffer_load_dwordx4 v15, s[4:7], s45 offen lds
    s_mov_b64 exec, -1
    s_mov_b32 s44, 3
    s_mul_i32 s46, s44, 196608
    s_add_u32 m0, s54, 24576
    s_nop 0
    buffer_load_dwordx4 v10, s[8:11], s46 offen offset:0 lds
    buffer_load_dwordx4 v10, s[8:11], s46 offen offset:1024 lds
    buffer_load_dwordx4 v10, s[8:11], s46 offen offset:2048 lds
    s_waitcnt vmcnt(15)
    s_barrier
    s_mov_b32 s44, 3
    s_mul_i32 s46, s44, 196608
    s_add_u32 s46, s46, 98304
    s_add_u32 m0, s54, 36864
    s_nop 0
    buffer_load_dwordx4 v10, s[8:11], s46 offen offset:0 lds
    buffer_load_dwordx4 v10, s[8:11], s46 offen offset:1024 lds
    buffer_load_dwordx4 v10, s[8:11], s46 offen offset:2048 lds
    s_mul_i32 s41, s2, 43
    s_mul_i32 s42, s71, 11
    s_add_u32 s41, s41, s42
    v_add_u32 v5, s41, v1
    v_lshlrev_b32 v5, 7, v5
    s_bfm_b64 exec, 11, 0
    buffer_load_dword v36, v5, s[16:19], 0 offen
    s_mov_b64 exec, -1
    s_mul_i32 s41, s2, 43
    s_mul_i32 s42, s71, 11
    s_add_u32 s41, s41, s42
    v_add_u32 v5, s41, v1
    v_lshlrev_b32 v5, 7, v5
    s_bfm_b64 exec, 11, 0
    buffer_load_dword v36, v5, s[20:23], 0 offen
    s_mov_b64 exec, -1
    s_waitcnt vmcnt(14)
    s_barrier
    s_add_u32 s46, s61, 0
    s_and_b32 s46, s46, 15
    s_mul_i32 s46, s46, 88064
    s_add_u32 m0, s54, 49152
    s_nop 0
    buffer_load_dwordx4 v12, s[16:19], s46 offen offset:0 lds
    buffer_load_dwordx4 v13, s[16:19], s46 offen offset:1024 lds
    buffer_load_dwordx4 v14, s[16:19], s46 offen offset:2048 lds
    s_waitcnt vmcnt(14)
    s_barrier
    s_add_u32 s46, s61, 1
    s_and_b32 s46, s46, 15
    s_mul_i32 s46, s46, 88064
    s_add_u32 m0, s54, 61440
    s_nop 0
    buffer_load_dwordx4 v12, s[16:19], s46 offen offset:0 lds
    buffer_load_dwordx4 v13, s[16:19], s46 offen offset:1024 lds
    buffer_load_dwordx4 v14, s[16:19], s46 offen offset:2048 lds
    s_waitcnt vmcnt(11)
    s_barrier
    s_add_u32 s46, s61, 2
    s_and_b32 s46, s46, 15
    s_mul_i32 s46, s46, 88064
    s_add_u32 m0, s54, 0
    s_nop 0
    buffer_load_dwordx4 v12, s[16:19], s46 offen offset:0 lds
    buffer_load_dwordx4 v13, s[16:19], s46 offen offset:1024 lds
    buffer_load_dwordx4 v14, s[16:19], s46 offen offset:2048 lds
    s_lshr_b32 s41, s2, 3
    s_mul_i32 s41, s41, 43
    s_mul_i32 s42, s71, 11
    s_add_u32 s41, s41, s42
    v_add_u32 v5, s41, v1
    v_lshlrev_b32 v5, 10, v5
    v_add_u32 v5, 384, v5
    s_bfm_b64 exec, 11, 0
    buffer_load_dword v36, v5, s[20:23], 0 offen
    s_mov_b64 exec, -1
    s_waitcnt vmcnt(12)
    s_barrier
    s_barrier
    s_barrier
    s_add_u32 s46, s35, 0
    s_and_b32 s46, s46, 7
    s_add_u32 s46, s46, 0
    s_lshl_b32 s46, s46, 15
    s_add_u32 m0, s57, 0
    s_nop 0
    buffer_load_dwordx4 v11, s[12:15], s46 offen lds
    s_add_u32 s46, s35, 1
    s_and_b32 s46, s46, 7
    s_add_u32 s46, s46, 0
    s_lshl_b32 s46, s46, 15
    s_add_u32 m0, s57, 4096
    s_nop 0
    buffer_load_dwordx4 v11, s[12:15], s46 offen lds
    s_add_u32 s46, s35, 2
    s_and_b32 s46, s46, 7
    s_add_u32 s46, s46, 0
    s_lshl_b32 s46, s46, 15
    s_add_u32 m0, s57, 8192
    s_nop 0
    buffer_load_dwordx4 v11, s[12:15], s46 offen lds
    s_add_u32 s46, s35, 3
    s_and_b32 s46, s46, 7
    s_add_u32 s46, s46, 0
    s_lshl_b32 s46, s46, 15
    s_add_u32 m0, s57, 12288
    s_nop 0
    buffer_load_dwordx4 v11, s[12:15], s46 offen lds
    s_add_u32 s46, s35, 4
    s_and_b32 s46, s46, 7
    s_add_u32 s46, s46, 0
    s_lshl_b32 s46, s46, 15
    s_add_u32 m0, s57, 16384
    s_nop 0
    buffer_load_dwordx4 v11, s[12:15], s46 offen lds
    s_add_u32 s46, s35, 5
    s_and_b32 s46, s46, 7
    s_add_u32 s46, s46, 0
    s_lshl_b32 s46, s46, 15
    s_add_u32 m0, s57, 20480
    s_nop 0
    buffer_load_dwordx4 v11, s[12:15], s46 offen lds
    s_add_u32 s46, s35, 6
    s_and_b32 s46, s46, 7
    s_add_u32 s46, s46, 0
    s_lshl_b32 s46, s46, 15
    s_add_u32 m0, s57, 24576
    s_nop 0
    buffer_load_dwordx4 v11, s[12:15], s46 offen lds
    s_add_u32 s46, s35, 7
    s_and_b32 s46, s46, 7
    s_add_u32 s46, s46, 0
    s_lshl_b32 s46, s46, 15
    s_add_u32 m0, s57, 28672
    s_nop 0
    buffer_load_dwordx4 v11, s[12:15], s46 offen lds
    s_add_u32 s46, s35, 0
    s_and_b32 s46, s46, 7
    s_add_u32 s46, s46, 8
    s_lshl_b32 s46, s46, 15
    s_add_u32 m0, s57, 32768
    s_nop 0
    buffer_load_dwordx4 v11, s[12:15], s46 offen lds
    s_add_u32 s46, s35, 1
    s_and_b32 s46, s46, 7
    s_add_u32 s46, s46, 8
    s_lshl_b32 s46, s46, 15
    s_add_u32 m0, s57, 36864
    s_nop 0
    buffer_load_dwordx4 v11, s[12:15], s46 offen lds
    s_add_u32 s46, s35, 2
    s_and_b32 s46, s46, 7
    s_add_u32 s46, s46, 8
    s_lshl_b32 s46, s46, 15
    s_add_u32 m0, s57, 40960
    s_nop 0
    buffer_load_dwordx4 v11, s[12:15], s46 offen lds
    s_add_u32 s46, s35, 3
    s_and_b32 s46, s46, 7
    s_add_u32 s46, s46, 8
    s_lshl_b32 s46, s46, 15
    s_add_u32 m0, s57, 45056
    s_nop 0
    buffer_load_dwordx4 v11, s[12:15], s46 offen lds
    s_add_u32 s46, s35, 4
    s_and_b32 s46, s46, 7
    s_add_u32 s46, s46, 8
    s_lshl_b32 s46, s46, 15
    s_add_u32 m0, s57, 49152
    s_nop 0
    buffer_load_dwordx4 v11, s[12:15], s46 offen lds
    s_add_u32 s46, s35, 5
    s_and_b32 s46, s46, 7
    s_add_u32 s46, s46, 8
    s_lshl_b32 s46, s46, 15
    s_add_u32 m0, s57, 53248
    s_nop 0
    buffer_load_dwordx4 v11, s[12:15], s46 offen lds
    s_add_u32 s46, s35, 6
    s_and_b32 s46, s46, 7
    s_add_u32 s46, s46, 8
    s_lshl_b32 s46, s46, 15
    s_add_u32 m0, s57, 57344
    s_nop 0
    buffer_load_dwordx4 v11, s[12:15], s46 offen lds
    s_add_u32 s46, s35, 7
    s_and_b32 s46, s46, 7
    s_add_u32 s46, s46, 8
    s_lshl_b32 s46, s46, 15
    s_add_u32 m0, s57, 61440
    s_nop 0
    buffer_load_dwordx4 v11, s[12:15], s46 offen lds
    s_add_u32 s46, s61, 3
    s_and_b32 s46, s46, 15
    s_mul_i32 s46, s46, 88064
    s_add_u32 m0, s54, 12288
    s_nop 0
    buffer_load_dwordx4 v12, s[16:19], s46 offen offset:0 lds
    buffer_load_dwordx4 v13, s[16:19], s46 offen offset:1024 lds
    buffer_load_dwordx4 v14, s[16:19], s46 offen offset:2048 lds
    s_add_u32 s46, s61, 4
    s_and_b32 s46, s46, 15
    s_mul_i32 s46, s46, 88064
    s_add_u32 m0, s54, 24576
    s_nop 0
    buffer_load_dwordx4 v12, s[16:19], s46 offen offset:0 lds
    buffer_load_dwordx4 v13, s[16:19], s46 offen offset:1024 lds
    buffer_load_dwordx4 v14, s[16:19], s46 offen offset:2048 lds
    s_add_u32 s46, s61, 5
    s_and_b32 s46, s46, 15
    s_mul_i32 s46, s46, 88064
    s_add_u32 m0, s54, 36864
    s_nop 0
    buffer_load_dwordx4 v12, s[16:19], s46 offen offset:0 lds
    buffer_load_dwordx4 v13, s[16:19], s46 offen offset:1024 lds
    buffer_load_dwordx4 v14, s[16:19], s46 offen offset:2048 lds
    s_add_u32 s46, s70, 0
    s_cmp_ge_u32 s46, 22
    s_cselect_b32 s45, 22, 0
    s_sub_u32 s46, s46, s45
    s_lshl_b32 s46, s46, 15
    buffer_load_dwordx4 v[40:43], v11, s[20:23], s46 offen
    s_add_u32 s46, s70, 0
    s_cmp_ge_u32 s46, 21
    s_cselect_b32 s45, 21, 0
    s_sub_u32 s46, s46, s45
    s_add_u32 s46, s46, 22
    s_lshl_b32 s46, s46, 15
    buffer_load_dwordx4 v[44:47], v11, s[20:23], s46 offen
    s_add_u32 s46, s70, 1
    s_cmp_ge_u32 s46, 22
    s_cselect_b32 s45, 22, 0
    s_sub_u32 s46, s46, s45
    s_lshl_b32 s46, s46, 15
    buffer_load_dwordx4 v[48:51], v11, s[20:23], s46 offen
    s_add_u32 s46, s70, 1
    s_cmp_ge_u32 s46, 21
    s_cselect_b32 s45, 21, 0
    s_sub_u32 s46, s46, s45
    s_add_u32 s46, s46, 22
    s_lshl_b32 s46, s46, 15
    buffer_load_dwordx4 v[52:55], v11, s[20:23], s46 offen
    s_add_u32 s46, s70, 2
    s_cmp_ge_u32 s46, 22
    s_cselect_b32 s45, 22, 0
    s_sub_u32 s46, s46, s45
    s_lshl_b32 s46, s46, 15
    buffer_load_dwordx4 v[56:59], v11, s[20:23], s46 offen
    s_waitcnt vmcnt(14)
    s_add_u32 s46, s70, 2
    s_cmp_ge_u32 s46, 21
    s_cselect_b32 s45, 21, 0
    s_sub_u32 s46, s46, s45
    s_add_u32 s46, s46, 22
    s_lshl_b32 s46, s46, 15
    buffer_load_dwordx4 v[60:63], v11, s[20:23], s46 offen
    s_add_u32 s46, s70, 3
    s_cmp_ge_u32 s46, 22
    s_cselect_b32 s45, 22, 0
    s_sub_u32 s46, s46, s45
    s_lshl_b32 s46, s46, 15
    buffer_load_dwordx4 v[64:67], v11, s[20:23], s46 offen
    s_add_u32 s46, s70, 3
    s_cmp_ge_u32 s46, 21
    s_cselect_b32 s45, 21, 0
    s_sub_u32 s46, s46, s45
    s_add_u32 s46, s46, 22
    s_lshl_b32 s46, s46, 15
    buffer_load_dwordx4 v[68:71], v11, s[20:23], s46 offen
    s_add_u32 s46, s70, 4
    s_cmp_ge_u32 s46, 22
    s_cselect_b32 s45, 22, 0
    s_sub_u32 s46, s46, s45
    s_lshl_b32 s46, s46, 15
    buffer_load_dwordx4 v[72:75], v11, s[20:23], s46 offen
    s_add_u32 s46, s70, 4
    s_cmp_ge_u32 s46, 21
    s_cselect_b32 s45, 21, 0
    s_sub_u32 s46, s46, s45
    s_add_u32 s46, s46, 22
    s_lshl_b32 s46, s46, 15
    buffer_load_dwordx4 v[76:79], v11, s[20:23], s46 offen
    s_barrier
    s_barrier
    s_add_u32 s46, s70, 5
    s_cmp_ge_u32 s46, 22
    s_cselect_b32 s45, 22, 0
    s_sub_u32 s46, s46, s45
    s_lshl_b32 s46, s46, 15
    buffer_load_dwordx4 v[80:83], v11, s[20:23], s46 offen
    s_add_u32 s46, s70, 5
    s_cmp_ge_u32 s46, 21
    s_cselect_b32 s45, 21, 0
    s_sub_u32 s46, s46, s45
    s_add_u32 s46, s46, 22
    s_lshl_b32 s46, s46, 15
    buffer_load_dwordx4 v[84:87], v11, s[20:23], s46 offen
    s_add_u32 s46, s70, 6
    s_cmp_ge_u32 s46, 22
    s_cselect_b32 s45, 22, 0
    s_sub_u32 s46, s46, s45
    s_lshl_b32 s46, s46, 15
    buffer_load_dwordx4 v[88:91], v11, s[20:23], s46 offen
    s_add_u32 s46, s70, 6
    s_cmp_ge_u32 s46, 21
    s_cselect_b32 s45, 21, 0
    s_sub_u32 s46, s46, s45
    s_add_u32 s46, s46, 22
    s_lshl_b32 s46, s46, 15
    buffer_load_dwordx4 v[92:95], v11, s[20:23], s46 offen
    s_add_u32 s46, s70, 7
    s_cmp_ge_u32 s46, 22
    s_cselect_b32 s45, 22, 0
    s_sub_u32 s46, s46, s45
    s_lshl_b32 s46, s46, 15
    buffer_load_dwordx4 v[96:99], v11, s[20:23], s46 offen
    s_add_u32 s46, s70, 7
    s_cmp_ge_u32 s46, 21
    s_cselect_b32 s45, 21, 0
    s_sub_u32 s46, s46, s45
    s_add_u32 s46, s46, 22
    s_lshl_b32 s46, s46, 15
    buffer_load_dwordx4 v[100:103], v11, s[20:23], s46 offen
    s_add_u32 s46, s70, 8
    s_cmp_ge_u32 s46, 22
    s_cselect_b32 s45, 22, 0
    s_sub_u32 s46, s46, s45
    s_lshl_b32 s46, s46, 15
    buffer_load_dwordx4 v[104:107], v11, s[20:23], s46 offen
    s_add_u32 s46, s70, 8
    s_cmp_ge_u32 s46, 21
    s_cselect_b32 s45, 21, 0
    s_sub_u32 s46, s46, s45
    s_add_u32 s46, s46, 22
    s_lshl_b32 s46, s46, 15
    buffer_load_dwordx4 v[108:111], v11, s[20:23], s46 offen
    s_add_u32 s46, s70, 9
    s_cmp_ge_u32 s46, 22
    s_cselect_b32 s45, 22, 0
    s_sub_u32 s46, s46, s45
    s_lshl_b32 s46, s46, 15
    buffer_load_dwordx4 v[112:115], v11, s[20:23], s46 offen
    s_add_u32 s46, s70, 9
    s_cmp_ge_u32 s46, 21
    s_cselect_b32 s45, 21, 0
    s_sub_u32 s46, s46, s45
    s_add_u32 s46, s46, 22
    s_lshl_b32 s46, s46, 15
    buffer_load_dwordx4 v[116:119], v11, s[20:23], s46 offen
    s_barrier
    s_mov_b32 s48, 200000
    s_movk_i32 s42, 4096
L_poll_2:
    buffer_load_dword v4, v17, s[28:31], s42 offen sc1
    s_waitcnt vmcnt(0)
    v_cmp_eq_u32 vcc, 1, v4
    s_nop 1
    s_cmp_eq_u64 vcc, -1
    s_cbranch_scc1 L_pdone_1
    s_sub_u32 s48, s48, 1
    s_cmp_eq_u32 s48, 0
    s_cbranch_scc1 L_pdone_1
    s_branch L_poll_2
L_pdone_1:
    s_add_u32 s44, s61, 0
    s_and_b32 s44, s44, 15
    s_lshl_b32 s44, s44, 10
    s_add_u32 s44, s44, s60
    s_lshl_b32 s45, s71, 14
    s_add_u32 m0, s45, 0
    s_nop 0
    buffer_load_dwordx4 v16, s[28:31], s44 offen sc1 lds
    s_add_u32 m0, s57, 155648
    s_nop 0
    buffer_load_dwordx4 v16, s[28:31], s62 offen sc1 lds
    s_add_u32 s44, s61, 1
    s_and_b32 s44, s44, 15
    s_lshl_b32 s44, s44, 10
    s_add_u32 s44, s44, s60
    s_lshl_b32 s45, s71, 14
    s_add_u32 m0, s45, 1024
    s_nop 0
    buffer_load_dwordx4 v16, s[28:31], s44 offen sc1 lds
    s_add_u32 s44, s61, 2
    s_and_b32 s44, s44, 15
    s_lshl_b32 s44, s44, 10
    s_add_u32 s44, s44, s60
    s_lshl_b32 s45, s71, 14
    s_add_u32 m0, s45, 2048
    s_nop 0
    buffer_load_dwordx4 v16, s[28:31], s44 offen sc1 lds
    s_add_u32 s44, s61, 3
    s_and_b32 s44, s44, 15
    s_lshl_b32 s44, s44, 10
    s_add_u32 s44, s44, s60
    s_lshl_b32 s45, s71, 14
    s_add_u32 m0, s45, 3072
    s_nop 0
    buffer_load_dwordx4 v16, s[28:31], s44 offen sc1 lds
    s_waitcnt vmcnt(3)
    s_barrier
    s_add_u32 s44, s61, 4
    s_and_b32 s44, s44, 15
    s_lshl_b32 s44, s44, 10
    s_add_u32 s44, s44, s60
    s_lshl_b32 s45, s71, 14
    s_add_u32 m0, s45, 4096
    s_nop 0
    buffer_load_dwordx4 v16, s[28:31], s44 offen sc1 lds
    s_add_u32 s44, s61, 5
    s_and_b32 s44, s44, 15
    s_lshl_b32 s44, s44, 10
    s_add_u32 s44, s44, s60
    s_lshl_b32 s45, s71, 14
    s_add_u32 m0, s45, 5120
    s_nop 0
    buffer_load_dwordx4 v16, s[28:31], s44 offen sc1 lds
    s_waitcnt vmcnt(4)
    s_barrier
    s_add_u32 s44, s61, 6
    s_and_b32 s44, s44, 15
    s_lshl_b32 s44, s44, 10
    s_add_u32 s44, s44, s60
    s_lshl_b32 s45, s71, 14
    s_add_u32 m0, s45, 6144
    s_nop 0
    buffer_load_dwordx4 v16, s[28:31], s44 offen sc1 lds
    s_add_u32 s44, s61, 7
    s_and_b32 s44, s44, 15
    s_lshl_b32 s44, s44, 10
    s_add_u32 s44, s44, s60
    s_lshl_b32 s45, s71, 14
    s_add_u32 m0, s45, 7168
    s_nop 0
    buffer_load_dwordx4 v16, s[28:31], s44 offen sc1 lds
    s_add_u32 s44, s61, 8
    s_and_b32 s44, s44, 15
    s_lshl_b32 s44, s44, 10
    s_add_u32 s44, s44, s60
    s_lshl_b32 s45, s71, 14
    s_add_u32 m0, s45, 8192
    s_nop 0
    buffer_load_dwordx4 v16, s[28:31], s44 offen sc1 lds
    s_waitcnt vmcnt(6)
    s_barrier
    s_add_u32 s44, s61, 9
    s_and_b32 s44, s44, 15
    s_lshl_b32 s44, s44, 10
    s_add_u32 s44, s44, s60
    s_lshl_b32 s45, s71, 14
    s_add_u32 m0, s45, 9216
    s_nop 0
    buffer_load_dwordx4 v16, s[28:31], s44 offen sc1 lds
    s_add_u32 s44, s61, 10
    s_and_b32 s44, s44, 15
    s_lshl_b32 s44, s44, 10
    s_add_u32 s44, s44, s60
    s_lshl_b32 s45, s71, 14
    s_add_u32 m0, s45, 10240
    s_nop 0
    buffer_load_dwordx4 v16, s[28:31], s44 offen sc1 lds
    s_add_u32 s44, s61, 11
    s_and_b32 s44, s44, 15
    s_lshl_b32 s44, s44, 10
    s_add_u32 s44, s44, s60
    s_lshl_b32 s45, s71, 14
    s_add_u32 m0, s45, 11264
    s_nop 0
    buffer_load_dwordx4 v16, s[28:31], s44 offen sc1 lds
    s_add_u32 s46, s61, 6
    s_and_b32 s46, s46, 15
    s_mul_i32 s46, s46, 88064
    s_add_u32 m0, s54, 49152
    s_nop 0
    buffer_load_dwordx4 v12, s[16:19], s46 offen offset:0 lds
    buffer_load_dwordx4 v13, s[16:19], s46 offen offset:1024 lds
    buffer_load_dwordx4 v14, s[16:19], s46 offen offset:2048 lds
    s_waitcnt vmcnt(11)
    s_barrier
    s_add_u32 s44, s61, 12
    s_and_b32 s44, s44, 15
    s_lshl_b32 s44, s44, 10
    s_add_u32 s44, s44, s60
    s_lshl_b32 s45, s71, 14
    s_add_u32 m0, s45, 12288
    s_nop 0
    buffer_load_dwordx4 v16, s[28:31], s44 offen sc1 lds
    s_add_u32 s44, s61, 13
    s_and_b32 s44, s44, 15
    s_lshl_b32 s44, s44, 10
    s_add_u32 s44, s44, s60
    s_lshl_b32 s45, s71, 14
    s_add_u32 m0, s45, 13312
    s_nop 0
    buffer_load_dwordx4 v16, s[28:31], s44 offen sc1 lds
    s_add_u32 s46, s61, 7
    s_and_b32 s46, s46, 15
    s_mul_i32 s46, s46, 88064
    s_add_u32 m0, s54, 61440
    s_nop 0
    buffer_load_dwordx4 v12, s[16:19], s46 offen offset:0 lds
    buffer_load_dwordx4 v13, s[16:19], s46 offen offset:1024 lds
    buffer_load_dwordx4 v14, s[16:19], s46 offen offset:2048 lds
    s_waitcnt vmcnt(15)
    s_barrier
    s_add_u32 s44, s61, 14
    s_and_b32 s44, s44, 15
    s_lshl_b32 s44, s44, 10
    s_add_u32 s44, s44, s60
    s_lshl_b32 s45, s71, 14
    s_add_u32 m0, s45, 14336
    s_nop 0
    buffer_load_dwordx4 v16, s[28:31], s44 offen sc1 lds
    s_add_u32 s44, s61, 15
    s_and_b32 s44, s44, 15
    s_lshl_b32 s44, s44, 10
    s_add_u32 s44, s44, s60
    s_lshl_b32 s45, s71, 14
    s_add_u32 m0, s45, 15360
    s_nop 0
    buffer_load_dwordx4 v16, s[28:31], s44 offen sc1 lds
    s_add_u32 s46, s61, 8
    s_and_b32 s46, s46, 15
    s_mul_i32 s46, s46, 88064
    s_add_u32 m0, s54, 0
    s_nop 0
    buffer_load_dwordx4 v12, s[16:19], s46 offen offset:0 lds
    buffer_load_dwordx4 v13, s[16:19], s46 offen offset:1024 lds
    buffer_load_dwordx4 v14, s[16:19], s46 offen offset:2048 lds
    s_waitcnt vmcnt(19)
    s_barrier
    s_add_u32 s46, s61, 9
    s_and_b32 s46, s46, 15
    s_mul_i32 s46, s46, 88064
    s_add_u32 m0, s54, 12288
    s_nop 0
    buffer_load_dwordx4 v12, s[16:19], s46 offen offset:0 lds
    buffer_load_dwordx4 v13, s[16:19], s46 offen offset:1024 lds
    buffer_load_dwordx4 v14, s[16:19], s46 offen offset:2048 lds
    s_waitcnt vmcnt(13)
    s_barrier
    s_add_u32 s46, s61, 10
    s_and_b32 s46, s46, 15
    s_mul_i32 s46, s46, 88064
    s_add_u32 m0, s54, 24576
    s_nop 0
    buffer_load_dwordx4 v12, s[16:19], s46 offen offset:0 lds
    buffer_load_dwordx4 v13, s[16:19], s46 offen offset:1024 lds
    buffer_load_dwordx4 v14, s[16:19], s46 offen offset:2048 lds
    s_waitcnt vmcnt(11)
    s_barrier
    s_add_u32 s46, s61, 11
    s_and_b32 s46, s46, 15
    s_mul_i32 s46, s46, 88064
    s_add_u32 m0, s54, 36864
    s_nop 0
    buffer_load_dwordx4 v12, s[16:19], s46 offen offset:0 lds
    buffer_load_dwordx4 v13, s[16:19], s46 offen offset:1024 lds
    buffer_load_dwordx4 v14, s[16:19], s46 offen offset:2048 lds
    s_waitcnt vmcnt(9)
    s_barrier
    s_add_u32 s46, s61, 12
    s_and_b32 s46, s46, 15
    s_mul_i32 s46, s46, 88064
    s_add_u32 m0, s54, 49152
    s_nop 0
    buffer_load_dwordx4 v12, s[16:19], s46 offen offset:0 lds
    buffer_load_dwordx4 v13, s[16:19], s46 offen offset:1024 lds
    buffer_load_dwordx4 v14, s[16:19], s46 offen offset:2048 lds
    s_waitcnt vmcnt(9)
    s_barrier
    s_add_u32 s46, s61, 13
    s_and_b32 s46, s46, 15
    s_mul_i32 s46, s46, 88064
    s_add_u32 m0, s54, 61440
    s_nop 0
    buffer_load_dwordx4 v12, s[16:19], s46 offen offset:0 lds
    buffer_load_dwordx4 v13, s[16:19], s46 offen offset:1024 lds
    buffer_load_dwordx4 v14, s[16:19], s46 offen offset:2048 lds
    s_waitcnt vmcnt(9)
    s_barrier
    s_add_u32 s46, s61, 14
    s_and_b32 s46, s46, 15
    s_mul_i32 s46, s46, 88064
    s_add_u32 m0, s54, 0
    s_nop 0
    buffer_load_dwordx4 v12, s[16:19], s46 offen offset:0 lds
    buffer_load_dwordx4 v13, s[16:19], s46 offen offset:1024 lds
    buffer_load_dwordx4 v14, s[16:19], s46 offen offset:2048 lds
    s_waitcnt vmcnt(9)
    s_barrier
    s_add_u32 s46, s61, 15
    s_and_b32 s46, s46, 15
    s_mul_i32 s46, s46, 88064
    s_add_u32 m0, s54, 12288
    s_nop 0
    buffer_load_dwordx4 v12, s[16:19], s46 offen offset:0 lds
    buffer_load_dwordx4 v13, s[16:19], s46 offen offset:1024 lds
    buffer_load_dwordx4 v14, s[16:19], s46 offen offset:2048 lds
    s_add_u32 s46, s70, 10
    s_cmp_ge_u32 s46, 22
    s_cselect_b32 s45, 22, 0
    s_sub_u32 s46, s46, s45
    s_lshl_b32 s46, s46, 15
    buffer_load_dwordx4 v[120:123], v11, s[20:23], s46 offen
    s_add_u32 s46, s70, 10
    s_cmp_ge_u32 s46, 21
    s_cselect_b32 s45, 21, 0
    s_sub_u32 s46, s46, s45
    s_add_u32 s46, s46, 22
    s_lshl_b32 s46, s46, 15
    buffer_load_dwordx4 v[124:127], v11, s[20:23], s46 offen
    s_add_u32 s46, s70, 11
    s_cmp_ge_u32 s46, 22
    s_cselect_b32 s45, 22, 0
    s_sub_u32 s46, s46, s45
    s_lshl_b32 s46, s46, 15
    buffer_load_dwordx4 v[128:131], v11, s[20:23], s46 offen
    s_add_u32 s46, s70, 11
    s_cmp_ge_u32 s46, 21
    s_cselect_b32 s45, 21, 0
    s_sub_u32 s46, s46, s45
    s_add_u32 s46, s46, 22
    s_lshl_b32 s46, s46, 15
    buffer_load_dwordx4 v[132:135], v11, s[20:23], s46 offen
    s_waitcnt vmcnt(13)
    s_barrier
    s_add_u32 s46, s70, 12
    s_cmp_ge_u32 s46, 22
    s_cselect_b32 s45, 22, 0
    s_sub_u32 s46, s46, s45
    s_lshl_b32 s46, s46, 15
    buffer_load_dwordx4 v[136:139], v11, s[20:23], s46 offen
    s_add_u32 s46, s70, 12
    s_cmp_ge_u32 s46, 21
    s_cselect_b32 s45, 21, 0
    s_sub_u32 s46, s46, s45
    s_add_u32 s46, s46, 22
    s_lshl_b32 s46, s46, 15
    buffer_load_dwordx4 v[140:143], v11, s[20:23], s46 offen
    s_add_u32 s46, s70, 13
    s_cmp_ge_u32 s46, 22
    s_cselect_b32 s45, 22, 0
    s_sub_u32 s46, s46, s45
    s_lshl_b32 s46, s46, 15
    buffer_load_dwordx4 v[144:147], v11, s[20:23], s46 offen
    s_add_u32 s46, s70, 13
    s_cmp_ge_u32 s46, 21
    s_cselect_b32 s45, 21, 0
    s_sub_u32 s46, s46, s45
    s_add_u32 s46, s46, 22
    s_lshl_b32 s46, s46, 15
    buffer_load_dwordx4 v[148:151], v11, s[20:23], s46 offen
    s_waitcnt vmcnt(14)
    s_barrier
    s_add_u32 s46, s70, 14
    s_cmp_ge_u32 s46, 22
    s_cselect_b32 s45, 22, 0
    s_sub_u32 s46, s46, s45
    s_lshl_b32 s46, s46, 15
    buffer_load_dwordx4 v[152:155], v11, s[20:23], s46 offen
    s_add_u32 s46, s70, 14
    s_cmp_ge_u32 s46, 21
    s_cselect_b32 s45, 21, 0
    s_sub_u32 s46, s46, s45
    s_add_u32 s46, s46, 22
    s_lshl_b32 s46, s46, 15
    buffer_load_dwordx4 v[156:159], v11, s[20:23], s46 offen
    s_add_u32 s46, s70, 15
    s_cmp_ge_u32 s46, 22
    s_cselect_b32 s45, 22, 0
    s_sub_u32 s46, s46, s45
    s_lshl_b32 s46, s46, 15
    buffer_load_dwordx4 v[160:163], v11, s[20:23], s46 offen
    s_add_u32 s46, s70, 15
    s_cmp_ge_u32 s46, 21
    s_cselect_b32 s45, 21, 0
    s_sub_u32 s46, s46, s45
    s_add_u32 s46, s46, 22
    s_lshl_b32 s46, s46, 15
    buffer_load_dwordx4 v[164:167], v11, s[20:23], s46 offen
    s_waitcnt vmcnt(15)
    s_barrier
    s_add_u32 s46, s70, 16
    s_cmp_ge_u32 s46, 22
    s_cselect_b32 s45, 22, 0
    s_sub_u32 s46, s46, s45
    s_lshl_b32 s46, s46, 15
    buffer_load_dwordx4 v[168:171], v11, s[20:23], s46 offen
    s_add_u32 s46, s70, 16
    s_cmp_ge_u32 s46, 21
    s_cselect_b32 s45, 21, 0
    s_sub_u32 s46, s46, s45
    s_add_u32 s46, s46, 22
    s_lshl_b32 s46, s46, 15
    buffer_load_dwordx4 v[172:175], v11, s[20:23], s46 offen
    s_add_u32 s46, s70, 17
    s_cmp_ge_u32 s46, 22
    s_cselect_b32 s45, 22, 0
    s_sub_u32 s46, s46, s45
    s_lshl_b32 s46, s46, 15
    buffer_load_dwordx4 v[176:179], v11, s[20:23], s46 offen
    s_add_u32 s46, s70, 17
    s_cmp_ge_u32 s46, 21
    s_cselect_b32 s45, 21, 0
    s_sub_u32 s46, s46, s45
    s_add_u32 s46, s46, 22
    s_lshl_b32 s46, s46, 15
    buffer_load_dwordx4 v[180:183], v11, s[20:23], s46 offen
    s_waitcnt vmcnt(16)
    s_barrier
    s_add_u32 s46, s70, 18
    s_cmp_ge_u32 s46, 22
    s_cselect_b32 s45, 22, 0
    s_sub_u32 s46, s46, s45
    s_lshl_b32 s46, s46, 15
    buffer_load_dwordx4 v[184:187], v11, s[20:23], s46 offen
    s_add_u32 s46, s70, 18
    s_cmp_ge_u32 s46, 21
    s_cselect_b32 s45, 21, 0
    s_sub_u32 s46, s46, s45
    s_add_u32 s46, s46, 22
    s_lshl_b32 s46, s46, 15
    buffer_load_dwordx4 v[188:191], v11, s[20:23], s46 offen
    s_add_u32 s46, s70, 19
    s_cmp_ge_u32 s46, 22
    s_cselect_b32 s45, 22, 0
    s_sub_u32 s46, s46, s45
    s_lshl_b32 s46, s46, 15
    buffer_load_dwordx4 v[192:195], v11, s[20:23], s46 offen
    s_add_u32 s46, s70, 19
    s_cmp_ge_u32 s46, 21
    s_cselect_b32 s45, 21, 0
    s_sub_u32 s46, s46, s45
    s_add_u32 s46, s46, 22
    s_lshl_b32 s46, s46, 15
    buffer_load_dwordx4 v[196:199], v11, s[20:23], s46 offen
    s_barrier
    s_barrier
    s_barrier
    ds_write_b128 v18, v[40:43] offset:0
    ds_write_b128 v19, v[44:47] offset:16384
    ds_write_b128 v18, v[48:51] offset:4096
    ds_write_b128 v19, v[52:55] offset:20480
    ds_write_b128 v18, v[56:59] offset:8192
    ds_write_b128 v19, v[60:63] offset:24576
    ds_write_b128 v18, v[64:67] offset:12288
    ds_write_b128 v19, v[68:71] offset:28672
    ds_write_b128 v18, v[72:75] offset:16384
    ds_write_b128 v19, v[76:79] offset:32768
    ds_write_b128 v18, v[80:83] offset:20480
    ds_write_b128 v19, v[84:87] offset:36864
    ds_write_b128 v18, v[88:91] offset:24576
    ds_write_b128 v19, v[92:95] offset:40960
    ds_write_b128 v18, v[96:99] offset:28672
    ds_write_b128 v19, v[100:103] offset:45056
    ds_write_b128 v18, v[104:107] offset:32768
    ds_write_b128 v19, v[108:111] offset:49152
    ds_write_b128 v18, v[112:115] offset:36864
    ds_write_b128 v19, v[116:119] offset:53248
    s_waitcnt vmcnt(19)
    ds_write_b128 v18, v[120:123] offset:40960
    s_waitcnt vmcnt(18)
    ds_write_b128 v19, v[124:127] offset:57344
    s_waitcnt vmcnt(17)
    ds_write_b128 v18, v[128:131] offset:45056
    s_waitcnt vmcnt(16)
    ds_write_b128 v19, v[132:135] offset:61440
    s_waitcnt vmcnt(15)
    ds_write_b128 v18, v[136:139] offset:49152
    s_waitcnt vmcnt(14)
    ds_write_b128 v20, v[140:143] offset:0
    s_waitcnt vmcnt(13)
    ds_write_b128 v18, v[144:147] offset:53248
    s_waitcnt vmcnt(12)
    ds_write_b128 v20, v[148:151] offset:4096
    s_waitcnt vmcnt(11)
    ds_write_b128 v18, v[152:155] offset:57344
    s_waitcnt vmcnt(10)
    ds_write_b128 v20, v[156:159] offset:8192
    s_waitcnt vmcnt(9)
    ds_write_b128 v18, v[160:163] offset:61440
    s_waitcnt vmcnt(8)
    ds_write_b128 v20, v[164:167] offset:12288
    s_waitcnt vmcnt(7)
    ds_write_b128 v19, v[168:171] offset:0
    s_waitcnt vmcnt(6)
    ds_write_b128 v20, v[172:175] offset:16384
    s_waitcnt vmcnt(5)
    ds_write_b128 v19, v[176:179] offset:4096
    s_waitcnt vmcnt(4)
    ds_write_b128 v20, v[180:183] offset:20480
    s_waitcnt vmcnt(3)
    ds_write_b128 v19, v[184:187] offset:8192
    s_waitcnt vmcnt(2)
    ds_write_b128 v20, v[188:191] offset:24576
    s_waitcnt vmcnt(1)
    ds_write_b128 v19, v[192:195] offset:12288
    s_waitcnt vmcnt(0)
    ds_write_b128 v20, v[196:199] offset:28672
    s_waitcnt vmcnt(0)
    s_waitcnt lgkmcnt(0)
    s_barrier
    s_barrier
    s_add_u32 s46, s70, 20
    s_cmp_ge_u32 s46, 22
    s_cselect_b32 s45, 22, 0
    s_sub_u32 s46, s46, s45
    s_lshl_b32 s46, s46, 15
    s_add_u32 m0, s57, 0
    s_nop 0
    buffer_load_dwordx4 v11, s[20:23], s46 offen lds
    s_add_u32 s46, s70, 21
    s_cmp_ge_u32 s46, 22
    s_cselect_b32 s45, 22, 0
    s_sub_u32 s46, s46, s45
    s_lshl_b32 s46, s46, 15
    s_add_u32 m0, s57, 4096
    s_nop 0
    buffer_load_dwordx4 v11, s[20:23], s46 offen lds
    s_add_u32 s46, s70, 20
    s_cmp_ge_u32 s46, 21
    s_cselect_b32 s45, 21, 0
    s_sub_u32 s46, s46, s45
    s_add_u32 s46, s46, 22
    s_lshl_b32 s46, s46, 15
    s_add_u32 m0, s57, 81920
    s_nop 0
    buffer_load_dwordx4 v11, s[20:23], s46 offen lds
    s_waitcnt vmcnt(0)
    s_barrier
    s_endpgm
L_compute:
    s_load_dwordx16 s[72:87], s[0:1], 0
    s_load_dwordx2 s[88:89], s[0:1], 64
    s_mul_i32 s47, s35, 43
    s_lshr_b32 s47, s47, 3
    s_mul_i32 s70, s35, 11
    s_lshr_b32 s70, s70, 2
    v_lshrrev_b32 v3, 4, v1
    s_waitcnt lgkmcnt(0)
    s_mov_b32 s4, s72
    s_and_b32 s5, s73, 0xffff
    s_mov_b32 s6, 2097152
    s_mov_b32 s7, 0x20000
    s_mov_b32 s24, s84
    s_and_b32 s25, s85, 0xffff
    s_mov_b32 s26, 2097152
    s_mov_b32 s27, 0x20000
    s_mov_b32 s28, s88
    s_and_b32 s29, s89, 0xffff
    s_mov_b32 s30, 16777216
    s_mov_b32 s31, 0x20000
    s_mov_b32 s32, s86
    s_mov_b32 s33, s87
    s_cmp_lg_u32 s36, 1
    s_cbranch_scc1 L_pf_3
    s_mov_b32 s8, s74
    s_and_b32 s9, s75, 0xffff
    s_mov_b32 s10, 1572864
    s_mov_b32 s11, 0x20000
    s_lshr_b32 s43, s2, 3
    s_mul_i32 s41, s43, 48
    v_add_u32 v4, s41, v1
    v_lshlrev_b32 v4, 10, v4
    v_add_u32 v4, 384, v4
    s_bfm_b64 exec, 48, 0
    buffer_load_dword v252, v4, s[8:11], 0 offen
    s_mov_b64 exec, -1
L_pf_3:
    s_cmp_lg_u32 s36, 0
    s_cbranch_scc1 L_pf_4
    s_mov_b32 s8, s74
    s_and_b32 s9, s75, 0xffff
    s_mov_b32 s10, 1572864
    s_mov_b32 s11, 0x20000
    s_mul_i32 s41, s2, 6
    s_add_u32 s41, s41, 4608
    v_add_u32 v4, s41, v1
    v_lshlrev_b32 v4, 7, v4
    s_bfm_b64 exec, 6, 0
    buffer_load_dword v252, v4, s[8:11], 0 offen
    s_mov_b64 exec, -1
L_pf_4:
    s_cmp_lg_u32 s36, 2
    s_cbranch_scc1 L_pf_5
    s_mov_b32 s12, s76
    s_and_b32 s13, s77, 0xffff
    s_mov_b32 s14, 524288
    s_mov_b32 s15, 0x20000
    s_lshr_b32 s43, s2, 3
    s_lshl_b32 s41, s43, 4
    v_add_u32 v4, s41, v1
    v_lshlrev_b32 v4, 10, v4
    v_add_u32 v4, 384, v4
    s_mov_b64 exec, 0xffff
    buffer_load_dword v252, v4, s[12:15], 0 offen
    s_mov_b64 exec, -1
L_pf_5:
    s_cmp_lg_u32 s36, 3
    s_cbranch_scc1 L_pf_6
    s_mov_b32 s12, s76
    s_and_b32 s13, s77, 0xffff
    s_mov_b32 s14, 524288
    s_mov_b32 s15, 0x20000
    s_lshl_b32 s41, s2, 4
    v_add_u32 v4, s41, v1
    v_lshlrev_b32 v4, 7, v4
    s_bfm_b64 exec, 16, 0
    buffer_load_dword v252, v4, s[12:15], 0 offen
    s_mov_b64 exec, -1
L_pf_6:
    s_and_b32 s38, s36, 1
    s_lshr_b32 s39, s36, 1
    s_lshl_b32 s40, s38, 1
    s_add_u32 s40, s40, s39
    v_and_b32 v2, 15, v1
    v_lshlrev_b32 v10, 4, v1
    s_mov_b32 s50, 0x3f803f80
    s_mov_b32 s51, 0x3f80
    s_mov_b32 s52, 0x3f800000
    s_add_u32 s49, s36, 1
    s_lshl_b32 s49, s49, 14
    v_mov_b32 v192, s50
    v_mov_b32 v193, s50
    v_mov_b32 v194, s50
    v_mov_b32 v195, s50
    s_lshl_b32 s43, s36, 12
    v_add_u32 v4, s43, v10
    s_mov_b64 exec, 0xff
    ds_write_b128 v4, v[192:195] offset:0
    ds_write_b128 v4, v[192:195] offset:2048
    s_mov_b64 exec, -1
    v_lshrrev_b32 v4, 1, v2
    v_xor_b32 v4, v4, v3
    v_lshlrev_b32 v4, 4, v4
    v_lshlrev_b32 v5, 7, v2
    v_add_u32 v240, v5, v4
    v_xor_b32 v241, 64, v240
    v_add_u32 v242, 0x10000, v240
    v_add_u32 v244, s49, v240
    v_add_u32 v243, 0x10000, v241
    v_add_u32 v245, s49, v241
    s_lshl_b32 s41, s38, 6
    v_xor_b32 v246, s41, v240
    s_lshl_b32 s41, s39, 11
    v_add_u32 v246, s41, v246
    v_lshrrev_b32 v4, 2, v2
    v_lshrrev_b32 v5, 1, v4
    v_and_b32 v6, 1, v3
    v_lshlrev_b32 v6, 1, v6
    v_add_u32 v5, v5, v6
    v_xor_b32 v5, s36, v5
    v_lshlrev_b32 v5, 5, v5
    v_lshlrev_b32 v4, 7, v4
    v_mul_u32_u24 v6, 3072, v3
    v_add3_u32 v4, v4, v5, v6
    v_and_b32 v5, 3, v1
    v_lshlrev_b32 v5, 3, v5
    v_add_u32 v4, v4, v5
    v_add_u32 v185, 81920, v4
    v_lshlrev_b32 v4, 2, v3
    v_add_u32 v4, 0, v4
    v_cmp_le_u32 s[54:55], v4, v2
    v_lshlrev_b32 v4, 2, v3
    v_add_u32 v4, 1, v4
    v_cmp_le_u32 s[56:57], v4, v2
    v_lshlrev_b32 v4, 2, v3
    v_add_u32 v4, 2, v4
    v_cmp_le_u32 s[58:59], v4, v2
    v_lshlrev_b32 v4, 2, v3
    v_add_u32 v4, 3, v4
    v_cmp_le_u32 s[60:61], v4, v2
    v_and_b32 v5, 3, v2
    v_cmp_eq_u32 s[62:63], 1, v5
    v_cmp_eq_u32 s[64:65], 2, v5
    v_cmp_eq_u32 s[66:67], 3, v5
    v_lshrrev_b32 v5, 2, v2
    v_cmp_eq_u32 s[68:69], v5, v3
    s_lshl_b32 s41, s34, 6
    s_lshl_b32 s42, s40, 4
    s_add_u32 s41, s41, s42
    v_add_u32 v4, s41, v2
    v_lshlrev_b32 v4, 10, v4
    v_lshlrev_b32 v5, 3, v3
    s_lshl_b32 s42, s35, 7
    v_add3_u32 v15, v4, v5, s42
    s_lshl_b32 s41, s34, 3
    v_mov_b32 v13, s41
    s_lshl_b32 s41, s34, 7
    s_add_u32 s41, s41, 11534336
    v_and_b32 v4, 31, v1
    v_lshlrev_b32 v4, 2, v4
    v_add_u32 v14, s41, v4
    s_lshl_b32 s42, s35, 2
    s_add_u32 s42, s42, s36
    s_lshl_b32 s42, s42, 2
    s_add_u32 s42, s42, s41
    v_mov_b32 v11, s42
    s_waitcnt lgkmcnt(0)
    v_lshlrev_b32 v4, 12, v1
    v_add_u32 v4, v4, v11
    v_mov_b32 v5, 0
    s_mov_b64 exec, 7
    buffer_store_dword v5, v4, s[28:31], 0 offen sc1
    s_mov_b64 exec, -1
    s_add_u32 s41, s36, 1
    s_lshl_b32 s41, s41, 7
    s_add_u32 s41, s41, 155648
    v_lshlrev_b32 v4, 3, v2
    v_add_u32 v184, s41, v4
    s_lshl_b32 s41, s36, 7
    s_add_u32 s41, s41, 156672
    v_add_u32 v190, s41, v4
    v_add_u32 v191, 155648, v4
    s_cmp_gt_u32 s35, 3
    s_cselect_b32 s42, 1, 0
    s_sub_u32 s41, s35, s42
    s_add_u32 s41, s41, 7
    s_sub_u32 s41, s41, s37
    s_cmp_ge_u32 s41, 7
    s_cselect_b32 s42, 7, 0
    s_sub_u32 s41, s41, s42
    s_cmp_eq_u32 s35, 3
    s_cselect_b32 s41, 7, s41
    s_lshl_b32 s41, s41, 11
    s_add_u32 s42, s40, 1
    s_lshl_b32 s42, s42, 14
    s_add_u32 s41, s41, s42
    v_lshrrev_b32 v4, 1, v2
    v_lshrrev_b32 v5, 1, v3
    v_xor_b32 v4, v4, v5
    v_lshlrev_b32 v5, 7, v2
    v_and_b32 v6, 1, v3
    v_lshlrev_b32 v6, 3, v6
    v_add3_u32 v5, v5, v6, s41
    v_xor_b32 v6, 0, v4
    v_lshlrev_b32 v6, 4, v6
    v_add_u32 v220, v5, v6
    v_xor_b32 v6, 2, v4
    v_lshlrev_b32 v6, 4, v6
    v_add_u32 v221, v5, v6
    v_xor_b32 v6, 4, v4
    v_lshlrev_b32 v6, 4, v6
    v_add_u32 v222, v5, v6
    v_xor_b32 v6, 6, v4
    v_lshlrev_b32 v6, 4, v6
    v_add_u32 v223, v5, v6
    v_mov_b32 v5, 0xf149f2ca
    v_add_u32 v4, 0, v2
    v_and_b32 v4, 1, v4
    v_cmp_eq_u32 vcc, 1, v4
    s_nop 1
    v_cndmask_b32 v180, 0, v5, vcc
    v_add_u32 v4, 1, v2
    v_and_b32 v4, 1, v4
    v_cmp_eq_u32 vcc, 1, v4
    s_nop 1
    v_cndmask_b32 v181, 0, v5, vcc
    s_cmp_eq_u32 s34, 0
    s_cselect_b32 s41, 0xf149f2ca, 0
    v_mov_b32 v6, s41
    v_cndmask_b32 v4, v6, 0, s[54:55]
    v_min_f32 v186, v180, v4
    v_cndmask_b32 v4, v6, 0, s[56:57]
    v_min_f32 v187, v181, v4
    v_cndmask_b32 v4, v6, 0, s[58:59]
    v_min_f32 v188, v180, v4
    v_cndmask_b32 v4, v6, 0, s[60:61]
    v_min_f32 v189, v181, v4
    v_mov_b32 v5, 0xffff
    v_mov_b32 v6, 0xffff0000
    v_cndmask_b32 v4, 0, v5, s[54:55]
    v_cndmask_b32 v7, 0, v6, s[56:57]
    v_or_b32 v182, v4, v7
    v_cndmask_b32 v4, 0, v5, s[58:59]
    v_cndmask_b32 v7, 0, v6, s[60:61]
    v_or_b32 v183, v4, v7
    v_lshlrev_b32 v8, 2, v3
    v_mov_b32 v5, 0x3f80
    v_mov_b32 v6, 0x3f800000
    v_add_u32 v4, 0, v8
    v_cmp_eq_u32 vcc, v4, v2
    s_nop 1
    v_cndmask_b32 v7, 0, v5, vcc
    v_add_u32 v4, 1, v8
    v_cmp_eq_u32 vcc, v4, v2
    s_nop 1
    v_cndmask_b32 v9, 0, v6, vcc
    v_or_b32 v218, v7, v9
    v_add_u32 v4, 2, v8
    v_cmp_eq_u32 vcc, v4, v2
    s_nop 1
    v_cndmask_b32 v7, 0, v5, vcc
    v_add_u32 v4, 3, v8
    v_cmp_eq_u32 vcc, v4, v2
    s_nop 1
    v_cndmask_b32 v9, 0, v6, vcc
    v_or_b32 v219, v7, v9
    s_lshl_b32 s41, s34, 16
    s_lshl_b32 s42, s35, 1
    s_add_u32 s42, s42, s39
    s_lshl_b32 s42, s42, 10
    s_add_u32 s93, s41, s42
    s_lshl_b32 s42, s38, 9
    v_lshlrev_b32 v4, 3, v1
    v_add_u32 v224, s42, v4
    s_waitcnt lgkmcnt(0)
    s_barrier
    ds_read_b64_tr_b16 v[68:69], v185 offset:1024
    ds_read_b64_tr_b16 v[70:71], v185 offset:1536
    ds_read_b128 v[24:27], v240 offset:0
    ds_read_b64_tr_b16 v[72:73], v185 offset:2048
    ds_read_b64_tr_b16 v[74:75], v185 offset:2560
    ds_read_b64_tr_b16 v[64:65], v185 offset:0
    ds_read_b64_tr_b16 v[66:67], v185 offset:512
    ds_read_b128 v[28:31], v240 offset:16384
    ds_read_b128 v[32:35], v240 offset:32768
    ds_read_b128 v[36:39], v240 offset:49152
    ds_read_b128 v[40:43], v242 offset:0
    ds_read_b128 v[88:91], v244 offset:0
    s_barrier
    s_waitcnt lgkmcnt(4)
    v_mfma_f32_16x16x32_bf16 v[124:127], v[68:71], v[24:27], 0
    ds_read_b64_tr_b16 v[80:81], v185 offset:13312
    v_mfma_f32_16x16x32_bf16 v[144:147], v[72:75], v[24:27], 0
    ds_read_b64_tr_b16 v[82:83], v185 offset:13824
    v_mfma_f32_16x16x32_bf16 v[104:107], v[64:67], v[24:27], 0
    ds_read_b128 v[44:47], v241 offset:0
    v_mfma_f32_16x16x32_bf16 v[128:131], v[68:71], v[28:31], 0
    ds_read_b64_tr_b16 v[84:85], v185 offset:14336
    v_mfma_f32_16x16x32_bf16 v[148:151], v[72:75], v[28:31], 0
    ds_read_b64_tr_b16 v[86:87], v185 offset:14848
    v_mfma_f32_16x16x32_bf16 v[108:111], v[64:67], v[28:31], 0
    ds_read_b64_tr_b16 v[76:77], v185 offset:12288
    s_waitcnt lgkmcnt(8)
    v_mfma_f32_16x16x32_bf16 v[132:135], v[68:71], v[32:35], 0
    ds_read_b64_tr_b16 v[78:79], v185 offset:12800
    v_mfma_f32_16x16x32_bf16 v[152:155], v[72:75], v[32:35], 0
    ds_read_b128 v[48:51], v241 offset:16384
    v_mfma_f32_16x16x32_bf16 v[112:115], v[64:67], v[32:35], 0
    ds_read_b128 v[52:55], v241 offset:32768
    v_mfma_f32_16x16x32_bf16 v[136:139], v[68:71], v[36:39], 0
    ds_read_b128 v[56:59], v241 offset:49152
    v_mfma_f32_16x16x32_bf16 v[156:159], v[72:75], v[36:39], 0
    ds_read_b128 v[60:63], v243 offset:0
    v_mfma_f32_16x16x32_bf16 v[116:119], v[64:67], v[36:39], 0
    ds_read_b128 v[92:95], v245 offset:0
    s_waitcnt lgkmcnt(12)
    v_mfma_f32_16x16x32_bf16 v[140:143], v[68:71], v[40:43], 0
    v_mfma_f32_16x16x32_bf16 v[160:163], v[72:75], v[40:43], 0
    v_mfma_f32_16x16x32_bf16 v[120:123], v[64:67], v[40:43], 0
    v_mfma_f32_16x16x32_bf16 v[164:167], v[192:195], v[88:91], 0
    v_mfma_f32_16x16x32_bf16 v[168:171], v[88:91], v[88:91], 0
    s_barrier
    s_waitcnt lgkmcnt(4)
    v_mfma_f32_16x16x32_bf16 v[124:127], v[80:83], v[44:47], v[124:127]
    ds_read_b64_tr_b16 v[68:69], v185 offset:25600
    v_mfma_f32_16x16x32_bf16 v[144:147], v[84:87], v[44:47], v[144:147]
    ds_read_b64_tr_b16 v[70:71], v185 offset:26112
    v_mfma_f32_16x16x32_bf16 v[104:107], v[76:79], v[44:47], v[104:107]
    ds_read_b128 v[24:27], v240 offset:2048
    v_mfma_f32_16x16x32_bf16 v[128:131], v[80:83], v[48:51], v[128:131]
    ds_read_b64_tr_b16 v[72:73], v185 offset:26624
    v_mfma_f32_16x16x32_bf16 v[148:151], v[84:87], v[48:51], v[148:151]
    ds_read_b64_tr_b16 v[74:75], v185 offset:27136
    v_mfma_f32_16x16x32_bf16 v[108:111], v[76:79], v[48:51], v[108:111]
    ds_read_b64_tr_b16 v[64:65], v185 offset:24576
    s_waitcnt lgkmcnt(8)
    v_mfma_f32_16x16x32_bf16 v[132:135], v[80:83], v[52:55], v[132:135]
    ds_read_b64_tr_b16 v[66:67], v185 offset:25088
    v_mfma_f32_16x16x32_bf16 v[152:155], v[84:87], v[52:55], v[152:155]
    ds_read_b128 v[28:31], v240 offset:18432
    v_mfma_f32_16x16x32_bf16 v[112:115], v[76:79], v[52:55], v[112:115]
    ds_read_b128 v[32:35], v240 offset:34816
    v_mfma_f32_16x16x32_bf16 v[136:139], v[80:83], v[56:59], v[136:139]
    ds_read_b128 v[36:39], v240 offset:51200
    v_mfma_f32_16x16x32_bf16 v[156:159], v[84:87], v[56:59], v[156:159]
    ds_read_b128 v[40:43], v242 offset:2048
    v_mfma_f32_16x16x32_bf16 v[116:119], v[76:79], v[56:59], v[116:119]
    ds_read_b128 v[88:91], v244 offset:2048
    s_waitcnt lgkmcnt(12)
    v_mfma_f32_16x16x32_bf16 v[140:143], v[80:83], v[60:63], v[140:143]
    v_mfma_f32_16x16x32_bf16 v[160:163], v[84:87], v[60:63], v[160:163]
    v_mfma_f32_16x16x32_bf16 v[120:123], v[76:79], v[60:63], v[120:123]
    v_mfma_f32_16x16x32_bf16 v[164:167], v[192:195], v[92:95], v[164:167]
    v_mfma_f32_16x16x32_bf16 v[168:171], v[92:95], v[92:95], v[168:171]
    s_barrier
    s_waitcnt lgkmcnt(4)
    v_mfma_f32_16x16x32_bf16 v[124:127], v[68:71], v[24:27], v[124:127]
    ds_read_b64_tr_b16 v[80:81], v185 offset:37888
    v_mfma_f32_16x16x32_bf16 v[144:147], v[72:75], v[24:27], v[144:147]
    ds_read_b64_tr_b16 v[82:83], v185 offset:38400
    v_mfma_f32_16x16x32_bf16 v[104:107], v[64:67], v[24:27], v[104:107]
    ds_read_b128 v[44:47], v241 offset:2048
    v_mfma_f32_16x16x32_bf16 v[128:131], v[68:71], v[28:31], v[128:131]
    ds_read_b64_tr_b16 v[84:85], v185 offset:38912
    v_mfma_f32_16x16x32_bf16 v[148:151], v[72:75], v[28:31], v[148:151]
    ds_read_b64_tr_b16 v[86:87], v185 offset:39424
    v_mfma_f32_16x16x32_bf16 v[108:111], v[64:67], v[28:31], v[108:111]
    ds_read_b64_tr_b16 v[76:77], v185 offset:36864
    s_waitcnt lgkmcnt(8)
    v_mfma_f32_16x16x32_bf16 v[132:135], v[68:71], v[32:35], v[132:135]
    ds_read_b64_tr_b16 v[78:79], v185 offset:37376
    v_mfma_f32_16x16x32_bf16 v[152:155], v[72:75], v[32:35], v[152:155]
    ds_read_b128 v[48:51], v241 offset:18432
    v_mfma_f32_16x16x32_bf16 v[112:115], v[64:67], v[32:35], v[112:115]
    ds_read_b128 v[52:55], v241 offset:34816
    v_mfma_f32_16x16x32_bf16 v[136:139], v[68:71], v[36:39], v[136:139]
    ds_read_b128 v[56:59], v241 offset:51200
    v_mfma_f32_16x16x32_bf16 v[156:159], v[72:75], v[36:39], v[156:159]
    ds_read_b128 v[60:63], v243 offset:2048
    v_mfma_f32_16x16x32_bf16 v[116:119], v[64:67], v[36:39], v[116:119]
    ds_read_b128 v[92:95], v245 offset:2048
    s_waitcnt lgkmcnt(12)
    v_mfma_f32_16x16x32_bf16 v[140:143], v[68:71], v[40:43], v[140:143]
    v_mfma_f32_16x16x32_bf16 v[160:163], v[72:75], v[40:43], v[160:163]
    v_mfma_f32_16x16x32_bf16 v[120:123], v[64:67], v[40:43], v[120:123]
    v_mfma_f32_16x16x32_bf16 v[164:167], v[192:195], v[88:91], v[164:167]
    v_mfma_f32_16x16x32_bf16 v[168:171], v[88:91], v[88:91], v[168:171]
    s_waitcnt vmcnt(0)
    s_barrier
    s_cmp_lg_u32 s36, 0
    s_cbranch_scc1 L_idone_7
    s_getreg_b32 s42, hwreg(HW_REG_XCC_ID, 0, 4)
    s_mul_i32 s43, s42, s42
    s_lshl_b32 s43, s43, 16
    s_lshl_b32 s42, s42, 8
    s_add_u32 s42, s42, s43
    s_add_u32 s42, s42, 1
    v_mov_b32 v4, s42
    s_mov_b64 exec, 1
    global_atomic_add v13, v4, s[32:33] sc1
    s_mov_b64 exec, -1
L_idone_7:
    s_waitcnt lgkmcnt(4)
    v_mfma_f32_16x16x32_bf16 v[124:127], v[80:83], v[44:47], v[124:127]
    ds_read_b64_tr_b16 v[68:69], v185 offset:50176
    v_mfma_f32_16x16x32_bf16 v[144:147], v[84:87], v[44:47], v[144:147]
    ds_read_b64_tr_b16 v[70:71], v185 offset:50688
    v_mfma_f32_16x16x32_bf16 v[104:107], v[76:79], v[44:47], v[104:107]
    ds_read_b128 v[24:27], v240 offset:4096
    v_mfma_f32_16x16x32_bf16 v[128:131], v[80:83], v[48:51], v[128:131]
    ds_read_b64_tr_b16 v[72:73], v185 offset:51200
    v_mfma_f32_16x16x32_bf16 v[148:151], v[84:87], v[48:51], v[148:151]
    ds_read_b64_tr_b16 v[74:75], v185 offset:51712
    v_mfma_f32_16x16x32_bf16 v[108:111], v[76:79], v[48:51], v[108:111]
    ds_read_b64_tr_b16 v[64:65], v185 offset:49152
    s_waitcnt lgkmcnt(8)
    v_mfma_f32_16x16x32_bf16 v[132:135], v[80:83], v[52:55], v[132:135]
    ds_read_b64_tr_b16 v[66:67], v185 offset:49664
    v_mfma_f32_16x16x32_bf16 v[152:155], v[84:87], v[52:55], v[152:155]
    ds_read_b128 v[28:31], v240 offset:20480
    v_mfma_f32_16x16x32_bf16 v[112:115], v[76:79], v[52:55], v[112:115]
    ds_read_b128 v[32:35], v240 offset:36864
    v_mfma_f32_16x16x32_bf16 v[136:139], v[80:83], v[56:59], v[136:139]
    ds_read_b128 v[36:39], v240 offset:53248
    v_mfma_f32_16x16x32_bf16 v[156:159], v[84:87], v[56:59], v[156:159]
    ds_read_b128 v[40:43], v242 offset:4096
    v_mfma_f32_16x16x32_bf16 v[116:119], v[76:79], v[56:59], v[116:119]
    ds_read_b128 v[88:91], v244 offset:4096
    s_waitcnt lgkmcnt(12)
    v_mfma_f32_16x16x32_bf16 v[140:143], v[80:83], v[60:63], v[140:143]
    v_mfma_f32_16x16x32_bf16 v[160:163], v[84:87], v[60:63], v[160:163]
    v_mfma_f32_16x16x32_bf16 v[120:123], v[76:79], v[60:63], v[120:123]
    v_mfma_f32_16x16x32_bf16 v[164:167], v[192:195], v[92:95], v[164:167]
    v_mfma_f32_16x16x32_bf16 v[168:171], v[92:95], v[92:95], v[168:171]
    s_barrier
    s_waitcnt lgkmcnt(4)
    v_mfma_f32_16x16x32_bf16 v[124:127], v[68:71], v[24:27], v[124:127]
    ds_read_b64_tr_b16 v[80:81], v185 offset:62464
    v_mfma_f32_16x16x32_bf16 v[144:147], v[72:75], v[24:27], v[144:147]
    ds_read_b64_tr_b16 v[82:83], v185 offset:62976
    v_mfma_f32_16x16x32_bf16 v[104:107], v[64:67], v[24:27], v[104:107]
    ds_read_b128 v[44:47], v241 offset:4096
    v_mfma_f32_16x16x32_bf16 v[128:131], v[68:71], v[28:31], v[128:131]
    ds_read_b64_tr_b16 v[84:85], v185 offset:63488
    v_mfma_f32_16x16x32_bf16 v[148:151], v[72:75], v[28:31], v[148:151]
    ds_read_b64_tr_b16 v[86:87], v185 offset:64000
    v_mfma_f32_16x16x32_bf16 v[108:111], v[64:67], v[28:31], v[108:111]
    ds_read_b64_tr_b16 v[76:77], v185 offset:61440
    s_waitcnt lgkmcnt(8)
    v_mfma_f32_16x16x32_bf16 v[132:135], v[68:71], v[32:35], v[132:135]
    ds_read_b64_tr_b16 v[78:79], v185 offset:61952
    v_mfma_f32_16x16x32_bf16 v[152:155], v[72:75], v[32:35], v[152:155]
    ds_read_b128 v[48:51], v241 offset:20480
    v_mfma_f32_16x16x32_bf16 v[112:115], v[64:67], v[32:35], v[112:115]
    ds_read_b128 v[52:55], v241 offset:36864
    v_mfma_f32_16x16x32_bf16 v[136:139], v[68:71], v[36:39], v[136:139]
    ds_read_b128 v[56:59], v241 offset:53248
    v_mfma_f32_16x16x32_bf16 v[156:159], v[72:75], v[36:39], v[156:159]
    ds_read_b128 v[60:63], v243 offset:4096
    v_mfma_f32_16x16x32_bf16 v[116:119], v[64:67], v[36:39], v[116:119]
    ds_read_b128 v[92:95], v245 offset:4096
    s_waitcnt lgkmcnt(12)
    v_mfma_f32_16x16x32_bf16 v[140:143], v[68:71], v[40:43], v[140:143]
    v_mfma_f32_16x16x32_bf16 v[160:163], v[72:75], v[40:43], v[160:163]
    v_mfma_f32_16x16x32_bf16 v[120:123], v[64:67], v[40:43], v[120:123]
    v_mfma_f32_16x16x32_bf16 v[164:167], v[192:195], v[88:91], v[164:167]
    v_mfma_f32_16x16x32_bf16 v[168:171], v[88:91], v[88:91], v[168:171]
    s_barrier
    s_waitcnt lgkmcnt(4)
    v_mfma_f32_16x16x32_bf16 v[124:127], v[80:83], v[44:47], v[124:127]
    ds_read_b64_tr_b16 v[68:69], v185 offset:1024
    v_mfma_f32_16x16x32_bf16 v[144:147], v[84:87], v[44:47], v[144:147]
    ds_read_b64_tr_b16 v[70:71], v185 offset:1536
    v_mfma_f32_16x16x32_bf16 v[104:107], v[76:79], v[44:47], v[104:107]
    ds_read_b128 v[24:27], v240 offset:6144
    v_mfma_f32_16x16x32_bf16 v[128:131], v[80:83], v[48:51], v[128:131]
    ds_read_b64_tr_b16 v[72:73], v185 offset:2048
    v_mfma_f32_16x16x32_bf16 v[148:151], v[84:87], v[48:51], v[148:151]
    ds_read_b64_tr_b16 v[74:75], v185 offset:2560
    v_mfma_f32_16x16x32_bf16 v[108:111], v[76:79], v[48:51], v[108:111]
    ds_read_b64_tr_b16 v[64:65], v185 offset:0
    s_waitcnt lgkmcnt(8)
    v_mfma_f32_16x16x32_bf16 v[132:135], v[80:83], v[52:55], v[132:135]
    ds_read_b64_tr_b16 v[66:67], v185 offset:512
    v_mfma_f32_16x16x32_bf16 v[152:155], v[84:87], v[52:55], v[152:155]
    ds_read_b128 v[28:31], v240 offset:22528
    v_mfma_f32_16x16x32_bf16 v[112:115], v[76:79], v[52:55], v[112:115]
    ds_read_b128 v[32:35], v240 offset:38912
    v_mfma_f32_16x16x32_bf16 v[136:139], v[80:83], v[56:59], v[136:139]
    ds_read_b128 v[36:39], v240 offset:55296
    v_mfma_f32_16x16x32_bf16 v[156:159], v[84:87], v[56:59], v[156:159]
    ds_read_b128 v[40:43], v242 offset:6144
    v_mfma_f32_16x16x32_bf16 v[116:119], v[76:79], v[56:59], v[116:119]
    ds_read_b128 v[88:91], v244 offset:6144
    s_waitcnt lgkmcnt(12)
    v_mfma_f32_16x16x32_bf16 v[140:143], v[80:83], v[60:63], v[140:143]
    v_mfma_f32_16x16x32_bf16 v[160:163], v[84:87], v[60:63], v[160:163]
    v_mfma_f32_16x16x32_bf16 v[120:123], v[76:79], v[60:63], v[120:123]
    v_mfma_f32_16x16x32_bf16 v[164:167], v[192:195], v[92:95], v[164:167]
    v_mfma_f32_16x16x32_bf16 v[168:171], v[92:95], v[92:95], v[168:171]
    s_barrier
    s_waitcnt lgkmcnt(4)
    v_mfma_f32_16x16x32_bf16 v[124:127], v[68:71], v[24:27], v[124:127]
    ds_read_b64_tr_b16 v[80:81], v185 offset:13312
    v_mfma_f32_16x16x32_bf16 v[144:147], v[72:75], v[24:27], v[144:147]
    ds_read_b64_tr_b16 v[82:83], v185 offset:13824
    v_mfma_f32_16x16x32_bf16 v[104:107], v[64:67], v[24:27], v[104:107]
    ds_read_b128 v[44:47], v241 offset:6144
    v_mfma_f32_16x16x32_bf16 v[128:131], v[68:71], v[28:31], v[128:131]
    ds_read_b64_tr_b16 v[84:85], v185 offset:14336
    v_mfma_f32_16x16x32_bf16 v[148:151], v[72:75], v[28:31], v[148:151]
    ds_read_b64_tr_b16 v[86:87], v185 offset:14848
    v_mfma_f32_16x16x32_bf16 v[108:111], v[64:67], v[28:31], v[108:111]
    ds_read_b64_tr_b16 v[76:77], v185 offset:12288
    s_waitcnt lgkmcnt(8)
    v_mfma_f32_16x16x32_bf16 v[132:135], v[68:71], v[32:35], v[132:135]
    ds_read_b64_tr_b16 v[78:79], v185 offset:12800
    v_mfma_f32_16x16x32_bf16 v[152:155], v[72:75], v[32:35], v[152:155]
    ds_read_b128 v[48:51], v241 offset:22528
    v_mfma_f32_16x16x32_bf16 v[112:115], v[64:67], v[32:35], v[112:115]
    ds_read_b128 v[52:55], v241 offset:38912
    v_mfma_f32_16x16x32_bf16 v[136:139], v[68:71], v[36:39], v[136:139]
    ds_read_b128 v[56:59], v241 offset:55296
    v_mfma_f32_16x16x32_bf16 v[156:159], v[72:75], v[36:39], v[156:159]
    ds_read_b128 v[60:63], v243 offset:6144
    v_mfma_f32_16x16x32_bf16 v[116:119], v[64:67], v[36:39], v[116:119]
    ds_read_b128 v[92:95], v245 offset:6144
    s_waitcnt lgkmcnt(12)
    v_mfma_f32_16x16x32_bf16 v[140:143], v[68:71], v[40:43], v[140:143]
    v_mfma_f32_16x16x32_bf16 v[160:163], v[72:75], v[40:43], v[160:163]
    v_mfma_f32_16x16x32_bf16 v[120:123], v[64:67], v[40:43], v[120:123]
    v_mfma_f32_16x16x32_bf16 v[164:167], v[192:195], v[88:91], v[164:167]
    v_mfma_f32_16x16x32_bf16 v[168:171], v[88:91], v[88:91], v[168:171]
    s_barrier
    s_waitcnt lgkmcnt(4)
    v_mfma_f32_16x16x32_bf16 v[124:127], v[80:83], v[44:47], v[124:127]
    ds_read_b64_tr_b16 v[68:69], v185 offset:25600
    v_mfma_f32_16x16x32_bf16 v[144:147], v[84:87], v[44:47], v[144:147]
    ds_read_b64_tr_b16 v[70:71], v185 offset:26112
    v_mfma_f32_16x16x32_bf16 v[104:107], v[76:79], v[44:47], v[104:107]
    ds_read_b128 v[24:27], v240 offset:8192
    v_mfma_f32_16x16x32_bf16 v[128:131], v[80:83], v[48:51], v[128:131]
    ds_read_b64_tr_b16 v[72:73], v185 offset:26624
    v_mfma_f32_16x16x32_bf16 v[148:151], v[84:87], v[48:51], v[148:151]
    ds_read_b64_tr_b16 v[74:75], v185 offset:27136
    v_mfma_f32_16x16x32_bf16 v[108:111], v[76:79], v[48:51], v[108:111]
    ds_read_b64_tr_b16 v[64:65], v185 offset:24576
    s_waitcnt lgkmcnt(8)
    v_mfma_f32_16x16x32_bf16 v[132:135], v[80:83], v[52:55], v[132:135]
    ds_read_b64_tr_b16 v[66:67], v185 offset:25088
    v_mfma_f32_16x16x32_bf16 v[152:155], v[84:87], v[52:55], v[152:155]
    ds_read_b128 v[28:31], v240 offset:24576
    v_mfma_f32_16x16x32_bf16 v[112:115], v[76:79], v[52:55], v[112:115]
    ds_read_b128 v[32:35], v240 offset:40960
    v_mfma_f32_16x16x32_bf16 v[136:139], v[80:83], v[56:59], v[136:139]
    ds_read_b128 v[36:39], v240 offset:57344
    v_mfma_f32_16x16x32_bf16 v[156:159], v[84:87], v[56:59], v[156:159]
    ds_read_b128 v[40:43], v242 offset:8192
    v_mfma_f32_16x16x32_bf16 v[116:119], v[76:79], v[56:59], v[116:119]
    ds_read_b128 v[88:91], v244 offset:8192
    s_waitcnt lgkmcnt(12)
    v_mfma_f32_16x16x32_bf16 v[140:143], v[80:83], v[60:63], v[140:143]
    v_mfma_f32_16x16x32_bf16 v[160:163], v[84:87], v[60:63], v[160:163]
    v_mfma_f32_16x16x32_bf16 v[120:123], v[76:79], v[60:63], v[120:123]
    v_mfma_f32_16x16x32_bf16 v[164:167], v[192:195], v[92:95], v[164:167]
    v_mfma_f32_16x16x32_bf16 v[168:171], v[92:95], v[92:95], v[168:171]
    s_barrier
    s_waitcnt lgkmcnt(4)
    v_mfma_f32_16x16x32_bf16 v[124:127], v[68:71], v[24:27], v[124:127]
    ds_read_b64_tr_b16 v[80:81], v185 offset:37888
    v_mfma_f32_16x16x32_bf16 v[144:147], v[72:75], v[24:27], v[144:147]
    ds_read_b64_tr_b16 v[82:83], v185 offset:38400
    v_mfma_f32_16x16x32_bf16 v[104:107], v[64:67], v[24:27], v[104:107]
    ds_read_b128 v[44:47], v241 offset:8192
    v_mfma_f32_16x16x32_bf16 v[128:131], v[68:71], v[28:31], v[128:131]
    ds_read_b64_tr_b16 v[84:85], v185 offset:38912
    v_mfma_f32_16x16x32_bf16 v[148:151], v[72:75], v[28:31], v[148:151]
    ds_read_b64_tr_b16 v[86:87], v185 offset:39424
    v_mfma_f32_16x16x32_bf16 v[108:111], v[64:67], v[28:31], v[108:111]
    ds_read_b64_tr_b16 v[76:77], v185 offset:36864
    s_waitcnt lgkmcnt(8)
    v_mfma_f32_16x16x32_bf16 v[132:135], v[68:71], v[32:35], v[132:135]
    ds_read_b64_tr_b16 v[78:79], v185 offset:37376
    v_mfma_f32_16x16x32_bf16 v[152:155], v[72:75], v[32:35], v[152:155]
    ds_read_b128 v[48:51], v241 offset:24576
    v_mfma_f32_16x16x32_bf16 v[112:115], v[64:67], v[32:35], v[112:115]
    ds_read_b128 v[52:55], v241 offset:40960
    v_mfma_f32_16x16x32_bf16 v[136:139], v[68:71], v[36:39], v[136:139]
    ds_read_b128 v[56:59], v241 offset:57344
    v_mfma_f32_16x16x32_bf16 v[156:159], v[72:75], v[36:39], v[156:159]
    ds_read_b128 v[60:63], v243 offset:8192
    v_mfma_f32_16x16x32_bf16 v[116:119], v[64:67], v[36:39], v[116:119]
    ds_read_b128 v[92:95], v245 offset:8192
    s_waitcnt lgkmcnt(12)
    v_mfma_f32_16x16x32_bf16 v[140:143], v[68:71], v[40:43], v[140:143]
    v_mfma_f32_16x16x32_bf16 v[160:163], v[72:75], v[40:43], v[160:163]
    v_mfma_f32_16x16x32_bf16 v[120:123], v[64:67], v[40:43], v[120:123]
    v_mfma_f32_16x16x32_bf16 v[164:167], v[192:195], v[88:91], v[164:167]
    v_mfma_f32_16x16x32_bf16 v[168:171], v[88:91], v[88:91], v[168:171]
    s_barrier
    s_waitcnt lgkmcnt(4)
    v_mfma_f32_16x16x32_bf16 v[124:127], v[80:83], v[44:47], v[124:127]
    ds_read_b64_tr_b16 v[68:69], v185 offset:50176
    v_mfma_f32_16x16x32_bf16 v[144:147], v[84:87], v[44:47], v[144:147]
    ds_read_b64_tr_b16 v[70:71], v185 offset:50688
    v_mfma_f32_16x16x32_bf16 v[104:107], v[76:79], v[44:47], v[104:107]
    ds_read_b128 v[24:27], v240 offset:10240
    v_mfma_f32_16x16x32_bf16 v[128:131], v[80:83], v[48:51], v[128:131]
    ds_read_b64_tr_b16 v[72:73], v185 offset:51200
    v_mfma_f32_16x16x32_bf16 v[148:151], v[84:87], v[48:51], v[148:151]
    ds_read_b64_tr_b16 v[74:75], v185 offset:51712
    v_mfma_f32_16x16x32_bf16 v[108:111], v[76:79], v[48:51], v[108:111]
    ds_read_b64_tr_b16 v[64:65], v185 offset:49152
    s_waitcnt lgkmcnt(8)
    v_mfma_f32_16x16x32_bf16 v[132:135], v[80:83], v[52:55], v[132:135]
    ds_read_b64_tr_b16 v[66:67], v185 offset:49664
    v_mfma_f32_16x16x32_bf16 v[152:155], v[84:87], v[52:55], v[152:155]
    ds_read_b128 v[28:31], v240 offset:26624
    v_mfma_f32_16x16x32_bf16 v[112:115], v[76:79], v[52:55], v[112:115]
    ds_read_b128 v[32:35], v240 offset:43008
    v_mfma_f32_16x16x32_bf16 v[136:139], v[80:83], v[56:59], v[136:139]
    ds_read_b128 v[36:39], v240 offset:59392
    v_mfma_f32_16x16x32_bf16 v[156:159], v[84:87], v[56:59], v[156:159]
    ds_read_b128 v[40:43], v242 offset:10240
    v_mfma_f32_16x16x32_bf16 v[116:119], v[76:79], v[56:59], v[116:119]
    ds_read_b128 v[88:91], v244 offset:10240
    s_waitcnt lgkmcnt(12)
    v_mfma_f32_16x16x32_bf16 v[140:143], v[80:83], v[60:63], v[140:143]
    v_mfma_f32_16x16x32_bf16 v[160:163], v[84:87], v[60:63], v[160:163]
    v_mfma_f32_16x16x32_bf16 v[120:123], v[76:79], v[60:63], v[120:123]
    global_load_dword v253, v13, s[32:33] sc1
    v_mfma_f32_16x16x32_bf16 v[164:167], v[192:195], v[92:95], v[164:167]
    v_mfma_f32_16x16x32_bf16 v[168:171], v[92:95], v[92:95], v[168:171]
    s_barrier
    s_waitcnt lgkmcnt(4)
    v_mfma_f32_16x16x32_bf16 v[124:127], v[68:71], v[24:27], v[124:127]
    ds_read_b64_tr_b16 v[80:81], v185 offset:62464
    v_mfma_f32_16x16x32_bf16 v[144:147], v[72:75], v[24:27], v[144:147]
    ds_read_b64_tr_b16 v[82:83], v185 offset:62976
    v_mfma_f32_16x16x32_bf16 v[104:107], v[64:67], v[24:27], v[104:107]
    ds_read_b128 v[44:47], v241 offset:10240
    v_mfma_f32_16x16x32_bf16 v[128:131], v[68:71], v[28:31], v[128:131]
    ds_read_b64_tr_b16 v[84:85], v185 offset:63488
    v_mfma_f32_16x16x32_bf16 v[148:151], v[72:75], v[28:31], v[148:151]
    ds_read_b64_tr_b16 v[86:87], v185 offset:64000
    v_mfma_f32_16x16x32_bf16 v[108:111], v[64:67], v[28:31], v[108:111]
    ds_read_b64_tr_b16 v[76:77], v185 offset:61440
    s_waitcnt lgkmcnt(8)
    v_mfma_f32_16x16x32_bf16 v[132:135], v[68:71], v[32:35], v[132:135]
    ds_read_b64_tr_b16 v[78:79], v185 offset:61952
    v_mfma_f32_16x16x32_bf16 v[152:155], v[72:75], v[32:35], v[152:155]
    ds_read_b128 v[48:51], v241 offset:26624
    v_mfma_f32_16x16x32_bf16 v[112:115], v[64:67], v[32:35], v[112:115]
    ds_read_b128 v[52:55], v241 offset:43008
    v_mfma_f32_16x16x32_bf16 v[136:139], v[68:71], v[36:39], v[136:139]
    ds_read_b128 v[56:59], v241 offset:59392
    v_mfma_f32_16x16x32_bf16 v[156:159], v[72:75], v[36:39], v[156:159]
    ds_read_b128 v[60:63], v243 offset:10240
    v_mfma_f32_16x16x32_bf16 v[116:119], v[64:67], v[36:39], v[116:119]
    ds_read_b128 v[92:95], v245 offset:10240
    s_waitcnt lgkmcnt(12)
    v_mfma_f32_16x16x32_bf16 v[140:143], v[68:71], v[40:43], v[140:143]
    v_mfma_f32_16x16x32_bf16 v[160:163], v[72:75], v[40:43], v[160:163]
    v_mfma_f32_16x16x32_bf16 v[120:123], v[64:67], v[40:43], v[120:123]
    v_mfma_f32_16x16x32_bf16 v[164:167], v[192:195], v[88:91], v[164:167]
    v_mfma_f32_16x16x32_bf16 v[168:171], v[88:91], v[88:91], v[168:171]
    s_barrier
    s_waitcnt lgkmcnt(4)
    v_mfma_f32_16x16x32_bf16 v[124:127], v[80:83], v[44:47], v[124:127]
    ds_read_b64_tr_b16 v[68:69], v185 offset:1024
    v_mfma_f32_16x16x32_bf16 v[144:147], v[84:87], v[44:47], v[144:147]
    ds_read_b64_tr_b16 v[70:71], v185 offset:1536
    v_mfma_f32_16x16x32_bf16 v[104:107], v[76:79], v[44:47], v[104:107]
    ds_read_b128 v[24:27], v240 offset:12288
    v_mfma_f32_16x16x32_bf16 v[128:131], v[80:83], v[48:51], v[128:131]
    ds_read_b64_tr_b16 v[72:73], v185 offset:2048
    v_mfma_f32_16x16x32_bf16 v[148:151], v[84:87], v[48:51], v[148:151]
    ds_read_b64_tr_b16 v[74:75], v185 offset:2560
    v_mfma_f32_16x16x32_bf16 v[108:111], v[76:79], v[48:51], v[108:111]
    ds_read_b64_tr_b16 v[64:65], v185 offset:0
    s_waitcnt lgkmcnt(8)
    v_mfma_f32_16x16x32_bf16 v[132:135], v[80:83], v[52:55], v[132:135]
    ds_read_b64_tr_b16 v[66:67], v185 offset:512
    v_mfma_f32_16x16x32_bf16 v[152:155], v[84:87], v[52:55], v[152:155]
    ds_read_b128 v[28:31], v240 offset:28672
    v_mfma_f32_16x16x32_bf16 v[112:115], v[76:79], v[52:55], v[112:115]
    ds_read_b128 v[32:35], v240 offset:45056
    v_mfma_f32_16x16x32_bf16 v[136:139], v[80:83], v[56:59], v[136:139]
    ds_read_b128 v[36:39], v240 offset:61440
    v_mfma_f32_16x16x32_bf16 v[156:159], v[84:87], v[56:59], v[156:159]
    ds_read_b128 v[40:43], v242 offset:12288
    v_mfma_f32_16x16x32_bf16 v[116:119], v[76:79], v[56:59], v[116:119]
    ds_read_b128 v[88:91], v244 offset:12288
    s_waitcnt lgkmcnt(12)
    v_mfma_f32_16x16x32_bf16 v[140:143], v[80:83], v[60:63], v[140:143]
    ds_read_b128 v[96:99], v246 offset:0
    v_mfma_f32_16x16x32_bf16 v[160:163], v[84:87], v[60:63], v[160:163]
    v_mfma_f32_16x16x32_bf16 v[120:123], v[76:79], v[60:63], v[120:123]
    v_mfma_f32_16x16x32_bf16 v[164:167], v[192:195], v[92:95], v[164:167]
    v_mfma_f32_16x16x32_bf16 v[168:171], v[92:95], v[92:95], v[168:171]
    s_barrier
    s_waitcnt lgkmcnt(5)
    v_mfma_f32_16x16x32_bf16 v[124:127], v[68:71], v[24:27], v[124:127]
    ds_read_b64_tr_b16 v[80:81], v185 offset:13312
    v_mfma_f32_16x16x32_bf16 v[144:147], v[72:75], v[24:27], v[144:147]
    ds_read_b64_tr_b16 v[82:83], v185 offset:13824
    v_mfma_f32_16x16x32_bf16 v[104:107], v[64:67], v[24:27], v[104:107]
    ds_read_b128 v[44:47], v241 offset:12288
    v_mfma_f32_16x16x32_bf16 v[128:131], v[68:71], v[28:31], v[128:131]
    ds_read_b64_tr_b16 v[84:85], v185 offset:14336
    v_mfma_f32_16x16x32_bf16 v[148:151], v[72:75], v[28:31], v[148:151]
    ds_read_b64_tr_b16 v[86:87], v185 offset:14848
    v_mfma_f32_16x16x32_bf16 v[108:111], v[64:67], v[28:31], v[108:111]
    ds_read_b64_tr_b16 v[76:77], v185 offset:12288
    s_waitcnt lgkmcnt(9)
    v_mfma_f32_16x16x32_bf16 v[132:135], v[68:71], v[32:35], v[132:135]
    ds_read_b64_tr_b16 v[78:79], v185 offset:12800
    v_mfma_f32_16x16x32_bf16 v[152:155], v[72:75], v[32:35], v[152:155]
    ds_read_b128 v[48:51], v241 offset:28672
    v_mfma_f32_16x16x32_bf16 v[112:115], v[64:67], v[32:35], v[112:115]
    ds_read_b128 v[52:55], v241 offset:45056
    v_mfma_f32_16x16x32_bf16 v[136:139], v[68:71], v[36:39], v[136:139]
    ds_read_b128 v[56:59], v241 offset:61440
    v_mfma_f32_16x16x32_bf16 v[156:159], v[72:75], v[36:39], v[156:159]
    ds_read_b128 v[60:63], v243 offset:12288
    v_mfma_f32_16x16x32_bf16 v[116:119], v[64:67], v[36:39], v[116:119]
    ds_read_b128 v[92:95], v245 offset:12288
    s_waitcnt lgkmcnt(12)
    v_mfma_f32_16x16x32_bf16 v[140:143], v[68:71], v[40:43], v[140:143]
    ds_read_b128 v[100:103], v246 offset:4096
    v_mfma_f32_16x16x32_bf16 v[160:163], v[72:75], v[40:43], v[160:163]
    v_mfma_f32_16x16x32_bf16 v[120:123], v[64:67], v[40:43], v[120:123]
    v_mfma_f32_16x16x32_bf16 v[164:167], v[192:195], v[88:91], v[164:167]
    v_mfma_f32_16x16x32_bf16 v[168:171], v[88:91], v[88:91], v[168:171]
    v_mfma_f32_16x16x32_bf16 v[172:175], v[192:195], v[96:99], 0
    v_mfma_f32_16x16x32_bf16 v[176:179], v[96:99], v[96:99], 0
    s_barrier
    s_waitcnt lgkmcnt(5)
    v_mfma_f32_16x16x32_bf16 v[124:127], v[80:83], v[44:47], v[124:127]
    ds_read_b64_tr_b16 v[68:69], v185 offset:25600
    v_mfma_f32_16x16x32_bf16 v[144:147], v[84:87], v[44:47], v[144:147]
    ds_read_b64_tr_b16 v[70:71], v185 offset:26112
    v_mfma_f32_16x16x32_bf16 v[104:107], v[76:79], v[44:47], v[104:107]
    ds_read_b128 v[24:27], v240 offset:14336
    v_mfma_f32_16x16x32_bf16 v[128:131], v[80:83], v[48:51], v[128:131]
    ds_read_b64_tr_b16 v[72:73], v185 offset:26624
    v_mfma_f32_16x16x32_bf16 v[148:151], v[84:87], v[48:51], v[148:151]
    ds_read_b64_tr_b16 v[74:75], v185 offset:27136
    v_mfma_f32_16x16x32_bf16 v[108:111], v[76:79], v[48:51], v[108:111]
    ds_read_b64_tr_b16 v[64:65], v185 offset:24576
    s_waitcnt lgkmcnt(9)
    v_mfma_f32_16x16x32_bf16 v[132:135], v[80:83], v[52:55], v[132:135]
    ds_read_b64_tr_b16 v[66:67], v185 offset:25088
    v_mfma_f32_16x16x32_bf16 v[152:155], v[84:87], v[52:55], v[152:155]
    ds_read_b128 v[28:31], v240 offset:30720
    v_mfma_f32_16x16x32_bf16 v[112:115], v[76:79], v[52:55], v[112:115]
    ds_read_b128 v[32:35], v240 offset:47104
    v_mfma_f32_16x16x32_bf16 v[136:139], v[80:83], v[56:59], v[136:139]
    ds_read_b128 v[36:39], v240 offset:63488
    v_mfma_f32_16x16x32_bf16 v[156:159], v[84:87], v[56:59], v[156:159]
    ds_read_b128 v[40:43], v242 offset:14336
    v_mfma_f32_16x16x32_bf16 v[116:119], v[76:79], v[56:59], v[116:119]
    ds_read_b128 v[88:91], v244 offset:14336
    s_waitcnt lgkmcnt(12)
    v_mfma_f32_16x16x32_bf16 v[140:143], v[80:83], v[60:63], v[140:143]
    ds_read_b128 v[96:99], v246 offset:8192
    v_mfma_f32_16x16x32_bf16 v[160:163], v[84:87], v[60:63], v[160:163]
    v_mfma_f32_16x16x32_bf16 v[120:123], v[76:79], v[60:63], v[120:123]
    v_mfma_f32_16x16x32_bf16 v[164:167], v[192:195], v[92:95], v[164:167]
    v_mfma_f32_16x16x32_bf16 v[168:171], v[92:95], v[92:95], v[168:171]
    v_mfma_f32_16x16x32_bf16 v[172:175], v[192:195], v[100:103], v[172:175]
    v_mfma_f32_16x16x32_bf16 v[176:179], v[100:103], v[100:103], v[176:179]
    s_barrier
    s_waitcnt vmcnt(0)
    s_mov_b32 s48, 200000
L_ic_9:
    v_readfirstlane_b32 s41, v253
    s_nop 0
    s_and_b32 s42, s41, 0xff
    s_cmp_ge_u32 s42, 8
    s_cbranch_scc1 L_icdone_8
    s_sub_u32 s48, s48, 1
    s_cmp_eq_u32 s48, 0
    s_cbranch_scc1 L_icdone_8
    s_sleep 4
    global_load_dword v253, v13, s[32:33] sc1
    s_waitcnt vmcnt(0)
    s_branch L_ic_9
L_icdone_8:
    s_getreg_b32 s42, hwreg(HW_REG_XCC_ID, 0, 4)
    s_mul_i32 s43, s42, s42
    s_lshl_b32 s43, s43, 19
    s_lshl_b32 s42, s42, 11
    s_add_u32 s42, s42, s43
    s_add_u32 s42, s42, 8
    s_cmp_eq_u32 s41, s42
    s_cselect_b32 s53, 1, 0
    s_waitcnt lgkmcnt(5)
    v_mfma_f32_16x16x32_bf16 v[124:127], v[68:71], v[24:27], v[124:127]
    ds_read_b64_tr_b16 v[80:81], v185 offset:37888
    v_mfma_f32_16x16x32_bf16 v[144:147], v[72:75], v[24:27], v[144:147]
    ds_read_b64_tr_b16 v[82:83], v185 offset:38400
    v_mfma_f32_16x16x32_bf16 v[104:107], v[64:67], v[24:27], v[104:107]
    ds_read_b128 v[44:47], v241 offset:14336
    v_mfma_f32_16x16x32_bf16 v[128:131], v[68:71], v[28:31], v[128:131]
    ds_read_b64_tr_b16 v[84:85], v185 offset:38912
    v_mfma_f32_16x16x32_bf16 v[148:151], v[72:75], v[28:31], v[148:151]
    ds_read_b64_tr_b16 v[86:87], v185 offset:39424
    v_mfma_f32_16x16x32_bf16 v[108:111], v[64:67], v[28:31], v[108:111]
    ds_read_b64_tr_b16 v[76:77], v185 offset:36864
    s_waitcnt lgkmcnt(9)
    v_mfma_f32_16x16x32_bf16 v[132:135], v[68:71], v[32:35], v[132:135]
    ds_read_b64_tr_b16 v[78:79], v185 offset:37376
    v_mfma_f32_16x16x32_bf16 v[152:155], v[72:75], v[32:35], v[152:155]
    ds_read_b128 v[48:51], v241 offset:30720
    v_mfma_f32_16x16x32_bf16 v[112:115], v[64:67], v[32:35], v[112:115]
    ds_read_b128 v[52:55], v241 offset:47104
    v_mfma_f32_16x16x32_bf16 v[136:139], v[68:71], v[36:39], v[136:139]
    ds_read_b128 v[56:59], v241 offset:63488
    v_mfma_f32_16x16x32_bf16 v[156:159], v[72:75], v[36:39], v[156:159]
    ds_read_b128 v[60:63], v243 offset:14336
    v_mfma_f32_16x16x32_bf16 v[116:119], v[64:67], v[36:39], v[116:119]
    ds_read_b128 v[92:95], v245 offset:14336
    s_waitcnt lgkmcnt(12)
    v_mfma_f32_16x16x32_bf16 v[140:143], v[68:71], v[40:43], v[140:143]
    ds_read_b128 v[100:103], v246 offset:12288
    v_mfma_f32_16x16x32_bf16 v[160:163], v[72:75], v[40:43], v[160:163]
    v_mfma_f32_16x16x32_bf16 v[120:123], v[64:67], v[40:43], v[120:123]
    v_mfma_f32_16x16x32_bf16 v[164:167], v[192:195], v[88:91], v[164:167]
    v_mfma_f32_16x16x32_bf16 v[168:171], v[88:91], v[88:91], v[168:171]
    v_mfma_f32_16x16x32_bf16 v[172:175], v[192:195], v[96:99], v[172:175]
    v_mfma_f32_16x16x32_bf16 v[176:179], v[96:99], v[96:99], v[176:179]
    s_barrier
    s_waitcnt lgkmcnt(5)
    v_mfma_f32_16x16x32_bf16 v[124:127], v[80:83], v[44:47], v[124:127]
    v_mfma_f32_16x16x32_bf16 v[144:147], v[84:87], v[44:47], v[144:147]
    v_mfma_f32_16x16x32_bf16 v[104:107], v[76:79], v[44:47], v[104:107]
    v_mfma_f32_16x16x32_bf16 v[128:131], v[80:83], v[48:51], v[128:131]
    v_mfma_f32_16x16x32_bf16 v[148:151], v[84:87], v[48:51], v[148:151]
    v_mfma_f32_16x16x32_bf16 v[108:111], v[76:79], v[48:51], v[108:111]
    s_waitcnt lgkmcnt(3)
    v_mfma_f32_16x16x32_bf16 v[132:135], v[80:83], v[52:55], v[132:135]
    v_mfma_f32_16x16x32_bf16 v[152:155], v[84:87], v[52:55], v[152:155]
    v_mfma_f32_16x16x32_bf16 v[112:115], v[76:79], v[52:55], v[112:115]
    v_mfma_f32_16x16x32_bf16 v[136:139], v[80:83], v[56:59], v[136:139]
    v_mfma_f32_16x16x32_bf16 v[156:159], v[84:87], v[56:59], v[156:159]
    v_mfma_f32_16x16x32_bf16 v[116:119], v[76:79], v[56:59], v[116:119]
    s_waitcnt lgkmcnt(0)
    v_mfma_f32_16x16x32_bf16 v[140:143], v[80:83], v[60:63], v[140:143]
    v_mfma_f32_16x16x32_bf16 v[160:163], v[84:87], v[60:63], v[160:163]
    v_mfma_f32_16x16x32_bf16 v[120:123], v[76:79], v[60:63], v[120:123]
    v_mfma_f32_16x16x32_bf16 v[164:167], v[192:195], v[92:95], v[164:167]
    v_mfma_f32_16x16x32_bf16 v[168:171], v[92:95], v[92:95], v[168:171]
    v_mfma_f32_16x16x32_bf16 v[172:175], v[192:195], v[100:103], v[172:175]
    v_mfma_f32_16x16x32_bf16 v[176:179], v[100:103], v[100:103], v[176:179]
    ds_read_b64 v[16:17], v220
    ds_read_b64 v[18:19], v221
    ds_read_b64 v[20:21], v222
    ds_read_b64 v[22:23], v223
    s_nop 1
    v_cndmask_b32 v165, v168, v169, s[62:63]
    v_cndmask_b32 v165, v165, v170, s[64:65]
    v_cndmask_b32 v165, v165, v171, s[66:67]
    v_cndmask_b32 v173, v176, v177, s[62:63]
    v_cndmask_b32 v173, v173, v178, s[64:65]
    v_cndmask_b32 v173, v173, v179, s[66:67]
    s_mov_b64 exec, s[68:69]
    ds_write_b64 v184, v[164:165]
    ds_write_b64 v190, v[172:173]
    s_mov_b64 exec, -1
    v_mov_b32_dpp v196, v104 row_newbcast:0 row_mask:0xf bank_mask:0xf
    v_mov_b32_dpp v200, v124 row_newbcast:0 row_mask:0xf bank_mask:0xf
    v_mov_b32_dpp v204, v144 row_newbcast:0 row_mask:0xf bank_mask:0xf
    v_mov_b32_dpp v197, v105 row_newbcast:0 row_mask:0xf bank_mask:0xf
    v_mov_b32_dpp v201, v125 row_newbcast:0 row_mask:0xf bank_mask:0xf
    v_mov_b32_dpp v205, v145 row_newbcast:0 row_mask:0xf bank_mask:0xf
    v_mov_b32_dpp v198, v106 row_newbcast:0 row_mask:0xf bank_mask:0xf
    v_mov_b32_dpp v202, v126 row_newbcast:0 row_mask:0xf bank_mask:0xf
    v_mov_b32_dpp v206, v146 row_newbcast:0 row_mask:0xf bank_mask:0xf
    v_mov_b32_dpp v199, v107 row_newbcast:0 row_mask:0xf bank_mask:0xf
    v_mov_b32_dpp v203, v127 row_newbcast:0 row_mask:0xf bank_mask:0xf
    v_mov_b32_dpp v207, v147 row_newbcast:0 row_mask:0xf bank_mask:0xf
    s_mov_b32 s41, 0xbb000000
    s_mov_b32 s42, 0x3b000000
    s_mov_b32 s43, 0x3727c5ac
    s_mov_b32 s44, 0x3eb8aa3b
    s_waitcnt lgkmcnt(0)
    s_barrier
    ds_read_b64 v[44:45], v191 offset:1024
    ds_read_b64 v[46:47], v191 offset:1152
    ds_read_b64 v[48:49], v191 offset:1280
    ds_read_b64 v[50:51], v191 offset:1408
    ds_read_b64 v[34:35], v191 offset:128
    ds_read_b64 v[36:37], v191 offset:256
    ds_read_b64 v[38:39], v191 offset:384
    ds_read_b64 v[40:41], v191 offset:512
    s_waitcnt lgkmcnt(4)
    v_pk_add_f32 v[44:45], v[44:45], v[46:47] op_sel:[0,0] op_sel_hi:[1,1]
    v_pk_add_f32 v[48:49], v[48:49], v[50:51] op_sel:[0,0] op_sel_hi:[1,1]
    v_pk_add_f32 v[32:33], v[44:45], v[48:49] op_sel:[0,0] op_sel_hi:[1,1]
    s_waitcnt lgkmcnt(0)
    v_mul_f32 v56, s41, v32
    v_mul_f32 v57, s41, v34
    v_mul_f32 v58, s41, v36
    v_mul_f32 v59, s41, v38
    v_mul_f32 v60, s41, v40
    v_mul_f32 v44, v56, v56
    v_mul_f32 v45, v57, v57
    v_mul_f32 v46, v58, v58
    v_mul_f32 v47, v59, v59
    v_mul_f32 v48, v60, v60
    v_fma_f32 v44, v33, s42, -v44
    v_fma_f32 v45, v35, s42, -v45
    v_fma_f32 v46, v37, s42, -v46
    v_fma_f32 v47, v39, s42, -v47
    v_fma_f32 v48, v41, s42, -v48
    v_max_f32 v44, 0, v44
    v_max_f32 v45, 0, v45
    v_max_f32 v46, 0, v46
    v_max_f32 v47, 0, v47
    v_max_f32 v48, 0, v48
    v_add_f32 v44, s43, v44
    v_add_f32 v45, s43, v45
    v_add_f32 v46, s43, v46
    v_add_f32 v47, s43, v47
    v_add_f32 v48, s43, v48
    v_rsq_f32 v64, v44
    v_rsq_f32 v65, v45
    v_rsq_f32 v66, v46
    v_rsq_f32 v67, v47
    v_rsq_f32 v68, v48
    v_pk_fma_f32 v[108:109], v[196:197], v[56:57], v[108:109] op_sel:[0,1,0] op_sel_hi:[1,1,1]
    v_pk_fma_f32 v[110:111], v[198:199], v[56:57], v[110:111] op_sel:[0,1,0] op_sel_hi:[1,1,1]
    v_pk_fma_f32 v[112:113], v[196:197], v[58:59], v[112:113] op_sel:[0,0,0] op_sel_hi:[1,0,1]
    v_pk_fma_f32 v[114:115], v[198:199], v[58:59], v[114:115] op_sel:[0,0,0] op_sel_hi:[1,0,1]
    v_pk_fma_f32 v[116:117], v[196:197], v[58:59], v[116:117] op_sel:[0,1,0] op_sel_hi:[1,1,1]
    v_pk_fma_f32 v[118:119], v[198:199], v[58:59], v[118:119] op_sel:[0,1,0] op_sel_hi:[1,1,1]
    v_pk_fma_f32 v[120:121], v[196:197], v[60:61], v[120:121] op_sel:[0,0,0] op_sel_hi:[1,0,1]
    v_pk_fma_f32 v[122:123], v[198:199], v[60:61], v[122:123] op_sel:[0,0,0] op_sel_hi:[1,0,1]
    v_pk_fma_f32 v[124:125], v[200:201], v[56:57], v[124:125] op_sel:[0,0,0] op_sel_hi:[1,0,1]
    v_pk_fma_f32 v[126:127], v[202:203], v[56:57], v[126:127] op_sel:[0,0,0] op_sel_hi:[1,0,1]
    v_pk_fma_f32 v[128:129], v[200:201], v[56:57], v[128:129] op_sel:[0,1,0] op_sel_hi:[1,1,1]
    v_pk_fma_f32 v[130:131], v[202:203], v[56:57], v[130:131] op_sel:[0,1,0] op_sel_hi:[1,1,1]
    v_pk_fma_f32 v[132:133], v[200:201], v[58:59], v[132:133] op_sel:[0,0,0] op_sel_hi:[1,0,1]
    v_pk_fma_f32 v[134:135], v[202:203], v[58:59], v[134:135] op_sel:[0,0,0] op_sel_hi:[1,0,1]
    v_pk_fma_f32 v[136:137], v[200:201], v[58:59], v[136:137] op_sel:[0,1,0] op_sel_hi:[1,1,1]
    v_pk_fma_f32 v[138:139], v[202:203], v[58:59], v[138:139] op_sel:[0,1,0] op_sel_hi:[1,1,1]
    v_pk_fma_f32 v[140:141], v[200:201], v[60:61], v[140:141] op_sel:[0,0,0] op_sel_hi:[1,0,1]
    v_pk_fma_f32 v[142:143], v[202:203], v[60:61], v[142:143] op_sel:[0,0,0] op_sel_hi:[1,0,1]
    v_cvt_pk_bf16_f32 v24, v108, v109
    v_cvt_pk_bf16_f32 v25, v110, v111
    v_cvt_pk_bf16_f32 v26, v112, v113
    v_cvt_pk_bf16_f32 v27, v114, v115
    v_cvt_pk_bf16_f32 v28, v116, v117
    v_cvt_pk_bf16_f32 v29, v118, v119
    v_cvt_pk_bf16_f32 v30, v120, v121
    v_cvt_pk_bf16_f32 v31, v122, v123
    v_pk_mul_f32 v[124:125], v[124:125], v[64:65] op_sel:[0,0] op_sel_hi:[1,0]
    v_pk_mul_f32 v[126:127], v[126:127], v[64:65] op_sel:[0,0] op_sel_hi:[1,0]
    v_cvt_pk_bf16_f32 v32, v124, v125
    v_cvt_pk_bf16_f32 v33, v126, v127
    v_pk_mul_f32 v[128:129], v[128:129], v[64:65] op_sel:[0,1] op_sel_hi:[1,1]
    v_pk_mul_f32 v[130:131], v[130:131], v[64:65] op_sel:[0,1] op_sel_hi:[1,1]
    v_cvt_pk_bf16_f32 v34, v128, v129
    v_cvt_pk_bf16_f32 v35, v130, v131
    v_pk_mul_f32 v[132:133], v[132:133], v[66:67] op_sel:[0,0] op_sel_hi:[1,0]
    v_pk_mul_f32 v[134:135], v[134:135], v[66:67] op_sel:[0,0] op_sel_hi:[1,0]
    v_cvt_pk_bf16_f32 v36, v132, v133
    v_cvt_pk_bf16_f32 v37, v134, v135
    v_pk_mul_f32 v[136:137], v[136:137], v[66:67] op_sel:[0,1] op_sel_hi:[1,1]
    v_pk_mul_f32 v[138:139], v[138:139], v[66:67] op_sel:[0,1] op_sel_hi:[1,1]
    v_cvt_pk_bf16_f32 v38, v136, v137
    v_cvt_pk_bf16_f32 v39, v138, v139
    v_pk_mul_f32 v[140:141], v[140:141], v[68:69] op_sel:[0,0] op_sel_hi:[1,0]
    v_pk_mul_f32 v[142:143], v[142:143], v[68:69] op_sel:[0,0] op_sel_hi:[1,0]
    v_cvt_pk_bf16_f32 v40, v140, v141
    v_cvt_pk_bf16_f32 v41, v142, v143
    v_pk_fma_f32 v[144:145], v[204:205], v[56:57], v[144:145] op_sel:[0,0,0] op_sel_hi:[1,0,1]
    v_pk_fma_f32 v[146:147], v[206:207], v[56:57], v[146:147] op_sel:[0,0,0] op_sel_hi:[1,0,1]
    v_mfma_f32_16x16x16_bf16 v[104:107], v[34:35], v[24:25], 0
    v_pk_mul_f32 v[144:145], v[144:145], v[64:65] op_sel:[0,0] op_sel_hi:[1,0]
    v_pk_mul_f32 v[146:147], v[146:147], v[64:65] op_sel:[0,0] op_sel_hi:[1,0]
    v_mfma_f32_16x16x16_bf16 v[108:111], v[32:33], v[24:25], 0
    v_cvt_pk_bf16_f32 v208, v144, v145
    v_cvt_pk_bf16_f32 v209, v146, v147
    v_pk_fma_f32 v[148:149], v[204:205], v[56:57], v[148:149] op_sel:[0,1,0] op_sel_hi:[1,1,1]
    v_pk_fma_f32 v[150:151], v[206:207], v[56:57], v[150:151] op_sel:[0,1,0] op_sel_hi:[1,1,1]
    v_mfma_f32_16x16x16_bf16 v[112:115], v[36:37], v[26:27], 0
    v_pk_mul_f32 v[148:149], v[148:149], v[64:65] op_sel:[0,1] op_sel_hi:[1,1]
    v_pk_mul_f32 v[150:151], v[150:151], v[64:65] op_sel:[0,1] op_sel_hi:[1,1]
    v_mfma_f32_16x16x16_bf16 v[116:119], v[34:35], v[26:27], 0
    v_cvt_pk_bf16_f32 v210, v148, v149
    v_cvt_pk_bf16_f32 v211, v150, v151
    v_pk_fma_f32 v[152:153], v[204:205], v[58:59], v[152:153] op_sel:[0,0,0] op_sel_hi:[1,0,1]
    v_pk_fma_f32 v[154:155], v[206:207], v[58:59], v[154:155] op_sel:[0,0,0] op_sel_hi:[1,0,1]
    v_mfma_f32_16x16x16_bf16 v[120:123], v[38:39], v[28:29], 0
    v_pk_mul_f32 v[152:153], v[152:153], v[66:67] op_sel:[0,0] op_sel_hi:[1,0]
    v_pk_mul_f32 v[154:155], v[154:155], v[66:67] op_sel:[0,0] op_sel_hi:[1,0]
    v_mfma_f32_16x16x16_bf16 v[124:127], v[36:37], v[28:29], 0
    v_cvt_pk_bf16_f32 v212, v152, v153
    v_cvt_pk_bf16_f32 v213, v154, v155
    v_pk_fma_f32 v[156:157], v[204:205], v[58:59], v[156:157] op_sel:[0,1,0] op_sel_hi:[1,1,1]
    v_pk_fma_f32 v[158:159], v[206:207], v[58:59], v[158:159] op_sel:[0,1,0] op_sel_hi:[1,1,1]
    v_mfma_f32_16x16x16_bf16 v[128:131], v[40:41], v[30:31], 0
    v_pk_mul_f32 v[156:157], v[156:157], v[66:67] op_sel:[0,1] op_sel_hi:[1,1]
    v_pk_mul_f32 v[158:159], v[158:159], v[66:67] op_sel:[0,1] op_sel_hi:[1,1]
    v_mfma_f32_16x16x16_bf16 v[132:135], v[38:39], v[30:31], 0
    v_cvt_pk_bf16_f32 v214, v156, v157
    v_cvt_pk_bf16_f32 v215, v158, v159
    v_pk_fma_f32 v[160:161], v[204:205], v[60:61], v[160:161] op_sel:[0,0,0] op_sel_hi:[1,0,1]
    v_pk_fma_f32 v[162:163], v[206:207], v[60:61], v[162:163] op_sel:[0,0,0] op_sel_hi:[1,0,1]
    v_pk_mul_f32 v[160:161], v[160:161], v[68:69] op_sel:[0,0] op_sel_hi:[1,0]
    v_pk_mul_f32 v[162:163], v[162:163], v[68:69] op_sel:[0,0] op_sel_hi:[1,0]
    v_cvt_pk_bf16_f32 v216, v160, v161
    v_cvt_pk_bf16_f32 v217, v162, v163
    v_mul_f32 v77, s44, v65
    v_mul_f32 v78, s44, v66
    v_mul_f32 v79, s44, v67
    v_mul_f32 v80, s44, v68
    v_mfma_f32_16x16x16_bf16 v[144:147], v[208:209], v[218:219], 0
    v_mfma_f32_16x16x16_bf16 v[148:151], v[210:211], v[218:219], 0
    v_mfma_f32_16x16x16_bf16 v[152:155], v[212:213], v[218:219], 0
    v_mfma_f32_16x16x16_bf16 v[156:159], v[214:215], v[218:219], 0
    v_mfma_f32_16x16x16_bf16 v[160:163], v[216:217], v[218:219], 0
    v_cndmask_b32 v104, v108, v104, s[54:55]
    v_cndmask_b32 v105, v109, v105, s[56:57]
    v_cndmask_b32 v106, v110, v106, s[58:59]
    v_cndmask_b32 v107, v111, v107, s[60:61]
    v_fma_f32 v104, v104, v77, v186
    v_fma_f32 v105, v105, v77, v187
    v_fma_f32 v106, v106, v77, v188
    v_fma_f32 v107, v107, v77, v189
    v_max3_f32 v137, v104, v105, v106
    v_max_f32 v137, v137, v107
    v_cndmask_b32 v112, v116, v112, s[54:55]
    v_cndmask_b32 v113, v117, v113, s[56:57]
    v_cndmask_b32 v114, v118, v114, s[58:59]
    v_cndmask_b32 v115, v119, v115, s[60:61]
    v_fma_f32 v112, v112, v78, v180
    v_fma_f32 v113, v113, v78, v181
    v_fma_f32 v114, v114, v78, v180
    v_fma_f32 v115, v115, v78, v181
    v_max3_f32 v138, v112, v113, v114
    v_max_f32 v138, v138, v115
    v_cndmask_b32 v120, v124, v120, s[54:55]
    v_cndmask_b32 v121, v125, v121, s[56:57]
    v_cndmask_b32 v122, v126, v122, s[58:59]
    v_cndmask_b32 v123, v127, v123, s[60:61]
    v_fma_f32 v120, v120, v79, v180
    v_fma_f32 v121, v121, v79, v181
    v_fma_f32 v122, v122, v79, v180
    v_fma_f32 v123, v123, v79, v181
    v_max3_f32 v139, v120, v121, v122
    v_max_f32 v139, v139, v123
    v_cndmask_b32 v128, v132, v128, s[54:55]
    v_cndmask_b32 v129, v133, v129, s[56:57]
    v_cndmask_b32 v130, v134, v130, s[58:59]
    v_cndmask_b32 v131, v135, v131, s[60:61]
    v_fma_f32 v128, v128, v80, v180
    v_fma_f32 v129, v129, v80, v181
    v_fma_f32 v130, v130, v80, v180
    v_fma_f32 v131, v131, v80, v181
    v_max3_f32 v140, v128, v129, v130
    v_max_f32 v140, v140, v131
    v_cvt_pk_bf16_f32 v44, v144, v145
    v_cvt_pk_bf16_f32 v45, v146, v147
    v_cvt_pk_bf16_f32 v46, v148, v149
    v_cvt_pk_bf16_f32 v47, v150, v151
    v_cvt_pk_bf16_f32 v48, v152, v153
    v_cvt_pk_bf16_f32 v49, v154, v155
    v_cvt_pk_bf16_f32 v50, v156, v157
    v_cvt_pk_bf16_f32 v51, v158, v159
    v_cvt_pk_bf16_f32 v52, v160, v161
    v_cvt_pk_bf16_f32 v53, v162, v163
    v_mov_b32 v73, v137
    v_mov_b32 v74, v138
    v_mov_b32 v75, v139
    v_mov_b32 v76, v140
    v_permlane16_swap_b32 v137, v73
    v_permlane16_swap_b32 v138, v74
    v_permlane16_swap_b32 v139, v75
    v_permlane16_swap_b32 v140, v76
    v_max_f32 v137, v137, v73
    v_max_f32 v138, v138, v74
    v_max_f32 v139, v139, v75
    v_max_f32 v140, v140, v76
    v_mov_b32 v73, v137
    v_mov_b32 v74, v138
    v_mov_b32 v75, v139
    v_mov_b32 v76, v140
    v_permlane32_swap_b32 v137, v73
    v_permlane32_swap_b32 v138, v74
    v_permlane32_swap_b32 v139, v75
    v_permlane32_swap_b32 v140, v76
    v_max_f32 v137, v137, v73
    v_max_f32 v138, v138, v74
    v_max_f32 v139, v139, v75
    v_max_f32 v140, v140, v76
    v_sub_f32 v104, v104, v137
    v_sub_f32 v105, v105, v137
    v_sub_f32 v106, v106, v137
    v_sub_f32 v107, v107, v137
    v_exp_f32 v104, v104
    v_exp_f32 v105, v105
    v_exp_f32 v106, v106
    v_exp_f32 v107, v107
    v_cvt_pk_bf16_f32 v152, v104, v105
    v_cvt_pk_bf16_f32 v153, v106, v107
    v_sub_f32 v112, v112, v138
    v_sub_f32 v113, v113, v138
    v_sub_f32 v114, v114, v138
    v_sub_f32 v115, v115, v138
    v_exp_f32 v112, v112
    v_exp_f32 v113, v113
    v_exp_f32 v114, v114
    v_exp_f32 v115, v115
    v_cvt_pk_bf16_f32 v154, v112, v113
    v_cvt_pk_bf16_f32 v155, v114, v115
    v_sub_f32 v120, v120, v139
    v_sub_f32 v121, v121, v139
    v_sub_f32 v122, v122, v139
    v_sub_f32 v123, v123, v139
    v_exp_f32 v120, v120
    v_exp_f32 v121, v121
    v_exp_f32 v122, v122
    v_exp_f32 v123, v123
    v_cvt_pk_bf16_f32 v156, v120, v121
    v_cvt_pk_bf16_f32 v157, v122, v123
    v_sub_f32 v128, v128, v140
    v_sub_f32 v129, v129, v140
    v_sub_f32 v130, v130, v140
    v_sub_f32 v131, v131, v140
    v_exp_f32 v128, v128
    v_exp_f32 v129, v129
    v_exp_f32 v130, v130
    v_exp_f32 v131, v131
    v_cvt_pk_bf16_f32 v158, v128, v129
    v_cvt_pk_bf16_f32 v159, v130, v131
    v_mfma_f32_16x16x16_bf16 v[104:107], v[192:193], v[152:153], 0
    v_and_b32 v160, v152, v182
    v_bfi_b32 v162, v182, 0, v152
    v_and_b32 v161, v153, v183
    v_bfi_b32 v163, v183, 0, v153
    v_mfma_f32_16x16x16_bf16 v[112:115], v[192:193], v[154:155], 0
    v_and_b32 v164, v154, v182
    v_bfi_b32 v166, v182, 0, v154
    v_and_b32 v165, v155, v183
    v_bfi_b32 v167, v183, 0, v155
    v_mfma_f32_16x16x16_bf16 v[120:123], v[192:193], v[156:157], 0
    v_and_b32 v168, v156, v182
    v_bfi_b32 v170, v182, 0, v156
    v_and_b32 v169, v157, v183
    v_bfi_b32 v171, v183, 0, v157
    v_mfma_f32_16x16x16_bf16 v[128:131], v[192:193], v[158:159], 0
    v_and_b32 v172, v158, v182
    v_bfi_b32 v174, v182, 0, v158
    v_and_b32 v173, v159, v183
    v_bfi_b32 v175, v183, 0, v159
    v_mfma_f32_16x16x16_bf16 v[108:111], v[46:47], v[160:161], 0
    v_mfma_f32_16x16x16_bf16 v[116:119], v[48:49], v[164:165], 0
    v_mfma_f32_16x16x16_bf16 v[124:127], v[50:51], v[168:169], 0
    v_mfma_f32_16x16x16_bf16 v[132:135], v[52:53], v[172:173], 0
    v_mfma_f32_16x16x16_bf16 v[108:111], v[44:45], v[162:163], v[108:111]
    v_mfma_f32_16x16x16_bf16 v[116:119], v[46:47], v[166:167], v[116:119]
    v_mfma_f32_16x16x16_bf16 v[124:127], v[48:49], v[170:171], v[124:127]
    v_mfma_f32_16x16x16_bf16 v[132:135], v[50:51], v[174:175], v[132:135]
    v_rcp_f32 v137, v104
    v_rcp_f32 v138, v112
    v_rcp_f32 v139, v120
    v_rcp_f32 v140, v128
    s_nop 0
    v_pk_mul_f32 v[108:109], v[108:109], v[136:137] op_sel:[0,1] op_sel_hi:[1,1]
    v_pk_mul_f32 v[110:111], v[110:111], v[136:137] op_sel:[0,1] op_sel_hi:[1,1]
    v_cvt_pk_bf16_f32 v24, v108, v109
    v_cvt_pk_bf16_f32 v25, v110, v111
    buffer_store_dwordx2 v[24:25], v224, s[28:31], s93 offen sc1
    s_add_u32 s93, s93, 16384
    v_pk_mul_f32 v[116:117], v[116:117], v[138:139] op_sel:[0,0] op_sel_hi:[1,0]
    v_pk_mul_f32 v[118:119], v[118:119], v[138:139] op_sel:[0,0] op_sel_hi:[1,0]
    v_cvt_pk_bf16_f32 v26, v116, v117
    v_cvt_pk_bf16_f32 v27, v118, v119
    buffer_store_dwordx2 v[26:27], v224, s[28:31], s93 offen sc1
    s_add_u32 s93, s93, 16384
    v_pk_mul_f32 v[124:125], v[124:125], v[138:139] op_sel:[0,1] op_sel_hi:[1,1]
    v_pk_mul_f32 v[126:127], v[126:127], v[138:139] op_sel:[0,1] op_sel_hi:[1,1]
    v_cvt_pk_bf16_f32 v28, v124, v125
    v_cvt_pk_bf16_f32 v29, v126, v127
    buffer_store_dwordx2 v[28:29], v224, s[28:31], s93 offen sc1
    s_add_u32 s93, s93, 16384
    v_pk_mul_f32 v[132:133], v[132:133], v[140:141] op_sel:[0,0] op_sel_hi:[1,0]
    v_pk_mul_f32 v[134:135], v[134:135], v[140:141] op_sel:[0,0] op_sel_hi:[1,0]
    v_cvt_pk_bf16_f32 v30, v132, v133
    v_cvt_pk_bf16_f32 v31, v134, v135
    buffer_store_dwordx2 v[30:31], v224, s[28:31], s93 offen sc1
    v_lshrrev_b32 v4, 2, v2
    v_lshlrev_b32 v5, 2, v3
    v_add_u32 v4, v4, v5
    v_lshrrev_b32 v5, 1, v4
    v_and_b32 v5, 3, v5
    v_lshlrev_b32 v4, 7, v4
    v_and_b32 v6, 3, v1
    v_lshlrev_b32 v6, 3, v6
    s_lshl_b32 s41, s39, 15
    v_add3_u32 v4, v4, v6, s41
    v_xor_b32 v6, 0, v5
    v_lshlrev_b32 v6, 5, v6
    v_add_u32 v152, v4, v6
    v_xor_b32 v6, 1, v5
    v_lshlrev_b32 v6, 5, v6
    v_add_u32 v153, v4, v6
    v_xor_b32 v6, 2, v5
    v_lshlrev_b32 v6, 5, v6
    v_add_u32 v154, v4, v6
    v_xor_b32 v6, 3, v5
    v_lshlrev_b32 v6, 5, v6
    v_add_u32 v155, v4, v6
    s_lshl_b32 s41, s34, 16
    s_lshl_b32 s42, s39, 13
    s_add_u32 s41, s41, s42
    v_lshlrev_b32 v7, 3, v1
    s_lshl_b32 s42, s40, 14
    s_add_u32 s43, s41, s42
    v_add_u32 v156, s43, v7
    s_xor_b32 s42, s40, 1
    s_lshl_b32 s42, s42, 14
    s_add_u32 s44, s41, s42
    v_add_u32 v157, s44, v7
    s_add_u32 s72, s35, 0
    s_and_b32 s72, s72, 7
    s_lshl_b32 s72, s72, 10
    s_add_u32 s73, s35, 1
    s_and_b32 s73, s73, 7
    s_lshl_b32 s73, s73, 10
    s_add_u32 s74, s35, 2
    s_and_b32 s74, s74, 7
    s_lshl_b32 s74, s74, 10
    s_add_u32 s75, s35, 3
    s_and_b32 s75, s75, 7
    s_lshl_b32 s75, s75, 10
    s_add_u32 s76, s35, 4
    s_and_b32 s76, s76, 7
    s_lshl_b32 s76, s76, 10
    s_add_u32 s77, s35, 5
    s_and_b32 s77, s77, 7
    s_lshl_b32 s77, s77, 10
    s_add_u32 s78, s35, 6
    s_and_b32 s78, s78, 7
    s_lshl_b32 s78, s78, 10
    s_add_u32 s79, s35, 7
    s_and_b32 s79, s79, 7
    s_lshl_b32 s79, s79, 10
    s_lshl_b32 s41, s36, 12
    s_add_u32 s41, s41, 65536
    v_add_u32 v158, s41, v10
    s_xor_b32 s42, s36, 2
    s_lshl_b32 s42, s42, 12
    s_add_u32 s42, s42, 65536
    v_add_u32 v159, s42, v10
    v_lshlrev_b32 v120, 16, v16
    v_and_b32 v121, 0xffff0000, v16
    v_lshlrev_b32 v122, 16, v17
    v_and_b32 v123, 0xffff0000, v17
    v_lshlrev_b32 v124, 16, v18
    v_and_b32 v125, 0xffff0000, v18
    v_lshlrev_b32 v126, 16, v19
    v_and_b32 v127, 0xffff0000, v19
    v_lshlrev_b32 v128, 16, v20
    v_and_b32 v129, 0xffff0000, v20
    v_lshlrev_b32 v130, 16, v21
    v_and_b32 v131, 0xffff0000, v21
    v_lshlrev_b32 v132, 16, v22
    v_and_b32 v133, 0xffff0000, v22
    v_lshlrev_b32 v134, 16, v23
    v_and_b32 v135, 0xffff0000, v23
    s_lshl_b32 s41, s34, 16
    s_lshl_b32 s42, s40, 14
    s_add_u32 s41, s41, s42
    s_lshl_b32 s42, s35, 11
    s_add_u32 s41, s41, s42
    s_add_u32 s80, s41, 2097152
    s_lshl_b32 s41, s34, 2
    s_add_u32 s41, s41, s40
    s_lshl_b32 s41, s41, 10
    s_lshl_b32 s42, s35, 7
    s_add_u32 s41, s41, s42
    s_add_u32 s81, s41, 10485760
    v_lshlrev_b32 v160, 3, v2
    s_waitcnt vmcnt(0)
    s_movk_i32 s41, 0
    v_mov_b32 v5, 1
    s_mov_b64 exec, 1
    s_cmp_eq_u32 s53, 0
    s_cbranch_scc1 L_xslow_10
    buffer_store_dword v5, v11, s[28:31], s41 offen
L_xjoin_11:
    s_mov_b64 exec, -1
    s_lshl_b32 s41, s34, 7
    s_lshl_b32 s42, s39, 6
    s_add_u32 s41, s41, s42
    s_add_u32 s41, s41, 11534336
    v_lshlrev_b32 v6, 2, v2
    v_add_u32 v14, s41, v6
    s_barrier
    ds_read_b64_tr_b16 v[88:89], v152 offset:0
    ds_read_b64_tr_b16 v[90:91], v152 offset:2048
    ds_read_b64_tr_b16 v[92:93], v153 offset:0
    ds_read_b64_tr_b16 v[94:95], v153 offset:2048
    ds_read_b64_tr_b16 v[96:97], v154 offset:0
    ds_read_b64_tr_b16 v[98:99], v154 offset:2048
    ds_read_b64_tr_b16 v[100:101], v155 offset:0
    ds_read_b64_tr_b16 v[102:103], v155 offset:2048
    s_mov_b32 s48, 200000
    s_movk_i32 s42, 0
L_poll_13:
    buffer_load_dword v4, v14, s[28:31], s42 offen sc1
    s_waitcnt vmcnt(0)
    v_cmp_eq_u32 vcc, 1, v4
    s_nop 1
    s_cmp_eq_u64 vcc, -1
    s_cbranch_scc1 L_pdone_12
    s_sub_u32 s48, s48, 1
    s_cmp_eq_u32 s48, 0
    s_cbranch_scc1 L_pdone_12
    s_branch L_poll_13
L_pdone_12:
    buffer_load_dwordx2 v[24:25], v156, s[28:31], s72 offen offset:0 sc1
    buffer_load_dwordx2 v[26:27], v156, s[28:31], s72 offen offset:512 sc1
    buffer_load_dwordx2 v[28:29], v157, s[28:31], s72 offen offset:0 sc1
    buffer_load_dwordx2 v[30:31], v157, s[28:31], s72 offen offset:512 sc1
    buffer_load_dwordx2 v[32:33], v156, s[28:31], s73 offen offset:0 sc1
    buffer_load_dwordx2 v[34:35], v156, s[28:31], s73 offen offset:512 sc1
    buffer_load_dwordx2 v[36:37], v157, s[28:31], s73 offen offset:0 sc1
    buffer_load_dwordx2 v[38:39], v157, s[28:31], s73 offen offset:512 sc1
    buffer_load_dwordx2 v[40:41], v156, s[28:31], s74 offen offset:0 sc1
    buffer_load_dwordx2 v[42:43], v156, s[28:31], s74 offen offset:512 sc1
    buffer_load_dwordx2 v[44:45], v157, s[28:31], s74 offen offset:0 sc1
    buffer_load_dwordx2 v[46:47], v157, s[28:31], s74 offen offset:512 sc1
    buffer_load_dwordx2 v[48:49], v156, s[28:31], s75 offen offset:0 sc1
    buffer_load_dwordx2 v[50:51], v156, s[28:31], s75 offen offset:512 sc1
    buffer_load_dwordx2 v[52:53], v157, s[28:31], s75 offen offset:0 sc1
    buffer_load_dwordx2 v[54:55], v157, s[28:31], s75 offen offset:512 sc1
    s_waitcnt vmcnt(12)
    s_waitcnt lgkmcnt(4)
    v_mfma_f32_16x16x32_bf16 v[120:123], v[88:91], v[24:27], v[120:123]
    ds_read_b64_tr_b16 v[104:105], v152 offset:4096
    buffer_load_dwordx2 v[56:57], v156, s[28:31], s76 offen offset:0 sc1
    v_mfma_f32_16x16x32_bf16 v[136:139], v[88:91], v[28:31], 0
    ds_read_b64_tr_b16 v[106:107], v152 offset:6144
    buffer_load_dwordx2 v[58:59], v156, s[28:31], s76 offen offset:512 sc1
    v_mfma_f32_16x16x32_bf16 v[124:127], v[92:95], v[24:27], v[124:127]
    ds_read_b64_tr_b16 v[108:109], v153 offset:4096
    buffer_load_dwordx2 v[60:61], v157, s[28:31], s76 offen offset:0 sc1
    v_mfma_f32_16x16x32_bf16 v[140:143], v[92:95], v[28:31], 0
    ds_read_b64_tr_b16 v[110:111], v153 offset:6144
    buffer_load_dwordx2 v[62:63], v157, s[28:31], s76 offen offset:512 sc1
    s_waitcnt lgkmcnt(4)
    v_mfma_f32_16x16x32_bf16 v[128:131], v[96:99], v[24:27], v[128:131]
    ds_read_b64_tr_b16 v[112:113], v154 offset:4096
    buffer_load_dwordx2 v[64:65], v156, s[28:31], s77 offen offset:0 sc1
    v_mfma_f32_16x16x32_bf16 v[144:147], v[96:99], v[28:31], 0
    ds_read_b64_tr_b16 v[114:115], v154 offset:6144
    buffer_load_dwordx2 v[66:67], v156, s[28:31], s77 offen offset:512 sc1
    v_mfma_f32_16x16x32_bf16 v[132:135], v[100:103], v[24:27], v[132:135]
    ds_read_b64_tr_b16 v[116:117], v155 offset:4096
    buffer_load_dwordx2 v[68:69], v157, s[28:31], s77 offen offset:0 sc1
    v_mfma_f32_16x16x32_bf16 v[148:151], v[100:103], v[28:31], 0
    ds_read_b64_tr_b16 v[118:119], v155 offset:6144
    buffer_load_dwordx2 v[70:71], v157, s[28:31], s77 offen offset:512 sc1
    s_waitcnt vmcnt(16)
    s_waitcnt lgkmcnt(4)
    v_mfma_f32_16x16x32_bf16 v[120:123], v[104:107], v[32:35], v[120:123]
    ds_read_b64_tr_b16 v[88:89], v152 offset:8192
    buffer_load_dwordx2 v[72:73], v156, s[28:31], s78 offen offset:0 sc1
    v_mfma_f32_16x16x32_bf16 v[136:139], v[104:107], v[36:39], v[136:139]
    ds_read_b64_tr_b16 v[90:91], v152 offset:10240
    buffer_load_dwordx2 v[74:75], v156, s[28:31], s78 offen offset:512 sc1
    v_mfma_f32_16x16x32_bf16 v[124:127], v[108:111], v[32:35], v[124:127]
    ds_read_b64_tr_b16 v[92:93], v153 offset:8192
    buffer_load_dwordx2 v[76:77], v157, s[28:31], s78 offen offset:0 sc1
    v_mfma_f32_16x16x32_bf16 v[140:143], v[108:111], v[36:39], v[140:143]
    ds_read_b64_tr_b16 v[94:95], v153 offset:10240
    buffer_load_dwordx2 v[78:79], v157, s[28:31], s78 offen offset:512 sc1
    s_waitcnt lgkmcnt(4)
    v_mfma_f32_16x16x32_bf16 v[128:131], v[112:115], v[32:35], v[128:131]
    ds_read_b64_tr_b16 v[96:97], v154 offset:8192
    v_mfma_f32_16x16x32_bf16 v[144:147], v[112:115], v[36:39], v[144:147]
    ds_read_b64_tr_b16 v[98:99], v154 offset:10240
    v_mfma_f32_16x16x32_bf16 v[132:135], v[116:119], v[32:35], v[132:135]
    ds_read_b64_tr_b16 v[100:101], v155 offset:8192
    v_mfma_f32_16x16x32_bf16 v[148:151], v[116:119], v[36:39], v[148:151]
    ds_read_b64_tr_b16 v[102:103], v155 offset:10240
    s_waitcnt vmcnt(16)
    s_waitcnt lgkmcnt(4)
    v_mfma_f32_16x16x32_bf16 v[120:123], v[88:91], v[40:43], v[120:123]
    ds_read_b64_tr_b16 v[104:105], v152 offset:12288
    buffer_load_dwordx2 v[80:81], v156, s[28:31], s79 offen offset:0 sc1
    v_mfma_f32_16x16x32_bf16 v[136:139], v[88:91], v[44:47], v[136:139]
    ds_read_b64_tr_b16 v[106:107], v152 offset:14336
    buffer_load_dwordx2 v[82:83], v156, s[28:31], s79 offen offset:512 sc1
    v_mfma_f32_16x16x32_bf16 v[124:127], v[92:95], v[40:43], v[124:127]
    ds_read_b64_tr_b16 v[108:109], v153 offset:12288
    buffer_load_dwordx2 v[84:85], v157, s[28:31], s79 offen offset:0 sc1
    v_mfma_f32_16x16x32_bf16 v[140:143], v[92:95], v[44:47], v[140:143]
    ds_read_b64_tr_b16 v[110:111], v153 offset:14336
    buffer_load_dwordx2 v[86:87], v157, s[28:31], s79 offen offset:512 sc1
    s_waitcnt lgkmcnt(4)
    v_mfma_f32_16x16x32_bf16 v[128:131], v[96:99], v[40:43], v[128:131]
    ds_read_b64_tr_b16 v[112:113], v154 offset:12288
    v_mfma_f32_16x16x32_bf16 v[144:147], v[96:99], v[44:47], v[144:147]
    ds_read_b64_tr_b16 v[114:115], v154 offset:14336
    v_mfma_f32_16x16x32_bf16 v[132:135], v[100:103], v[40:43], v[132:135]
    ds_read_b64_tr_b16 v[116:117], v155 offset:12288
    v_mfma_f32_16x16x32_bf16 v[148:151], v[100:103], v[44:47], v[148:151]
    ds_read_b64_tr_b16 v[118:119], v155 offset:14336
    s_waitcnt vmcnt(16)
    s_waitcnt lgkmcnt(4)
    v_mfma_f32_16x16x32_bf16 v[120:123], v[104:107], v[48:51], v[120:123]
    ds_read_b64_tr_b16 v[88:89], v152 offset:16384
    v_mfma_f32_16x16x32_bf16 v[136:139], v[104:107], v[52:55], v[136:139]
    ds_read_b64_tr_b16 v[90:91], v152 offset:18432
    v_mfma_f32_16x16x32_bf16 v[124:127], v[108:111], v[48:51], v[124:127]
    ds_read_b64_tr_b16 v[92:93], v153 offset:16384
    v_mfma_f32_16x16x32_bf16 v[140:143], v[108:111], v[52:55], v[140:143]
    ds_read_b64_tr_b16 v[94:95], v153 offset:18432
    s_waitcnt lgkmcnt(4)
    v_mfma_f32_16x16x32_bf16 v[128:131], v[112:115], v[48:51], v[128:131]
    ds_read_b64_tr_b16 v[96:97], v154 offset:16384
    v_mfma_f32_16x16x32_bf16 v[144:147], v[112:115], v[52:55], v[144:147]
    ds_read_b64_tr_b16 v[98:99], v154 offset:18432
    v_mfma_f32_16x16x32_bf16 v[132:135], v[116:119], v[48:51], v[132:135]
    ds_read_b64_tr_b16 v[100:101], v155 offset:16384
    v_mfma_f32_16x16x32_bf16 v[148:151], v[116:119], v[52:55], v[148:151]
    ds_read_b64_tr_b16 v[102:103], v155 offset:18432
    s_waitcnt vmcnt(12)
    s_waitcnt lgkmcnt(4)
    v_mfma_f32_16x16x32_bf16 v[120:123], v[88:91], v[56:59], v[120:123]
    ds_read_b64_tr_b16 v[104:105], v152 offset:20480
    v_mfma_f32_16x16x32_bf16 v[136:139], v[88:91], v[60:63], v[136:139]
    ds_read_b64_tr_b16 v[106:107], v152 offset:22528
    v_mfma_f32_16x16x32_bf16 v[124:127], v[92:95], v[56:59], v[124:127]
    ds_read_b64_tr_b16 v[108:109], v153 offset:20480
    v_mfma_f32_16x16x32_bf16 v[140:143], v[92:95], v[60:63], v[140:143]
    ds_read_b64_tr_b16 v[110:111], v153 offset:22528
    s_waitcnt lgkmcnt(4)
    v_mfma_f32_16x16x32_bf16 v[128:131], v[96:99], v[56:59], v[128:131]
    ds_read_b64_tr_b16 v[112:113], v154 offset:20480
    v_mfma_f32_16x16x32_bf16 v[144:147], v[96:99], v[60:63], v[144:147]
    ds_read_b64_tr_b16 v[114:115], v154 offset:22528
    v_mfma_f32_16x16x32_bf16 v[132:135], v[100:103], v[56:59], v[132:135]
    ds_read_b64_tr_b16 v[116:117], v155 offset:20480
    v_mfma_f32_16x16x32_bf16 v[148:151], v[100:103], v[60:63], v[148:151]
    ds_read_b64_tr_b16 v[118:119], v155 offset:22528
    s_waitcnt vmcnt(8)
    s_waitcnt lgkmcnt(4)
    v_mfma_f32_16x16x32_bf16 v[120:123], v[104:107], v[64:67], v[120:123]
    ds_read_b64_tr_b16 v[88:89], v152 offset:24576
    v_mfma_f32_16x16x32_bf16 v[136:139], v[104:107], v[68:71], v[136:139]
    ds_read_b64_tr_b16 v[90:91], v152 offset:26624
    v_mfma_f32_16x16x32_bf16 v[124:127], v[108:111], v[64:67], v[124:127]
    ds_read_b64_tr_b16 v[92:93], v153 offset:24576
    v_mfma_f32_16x16x32_bf16 v[140:143], v[108:111], v[68:71], v[140:143]
    ds_read_b64_tr_b16 v[94:95], v153 offset:26624
    s_waitcnt lgkmcnt(4)
    v_mfma_f32_16x16x32_bf16 v[128:131], v[112:115], v[64:67], v[128:131]
    ds_read_b64_tr_b16 v[96:97], v154 offset:24576
    v_mfma_f32_16x16x32_bf16 v[144:147], v[112:115], v[68:71], v[144:147]
    ds_read_b64_tr_b16 v[98:99], v154 offset:26624
    v_mfma_f32_16x16x32_bf16 v[132:135], v[116:119], v[64:67], v[132:135]
    ds_read_b64_tr_b16 v[100:101], v155 offset:24576
    v_mfma_f32_16x16x32_bf16 v[148:151], v[116:119], v[68:71], v[148:151]
    ds_read_b64_tr_b16 v[102:103], v155 offset:26624
    s_waitcnt vmcnt(4)
    s_waitcnt lgkmcnt(4)
    v_mfma_f32_16x16x32_bf16 v[120:123], v[88:91], v[72:75], v[120:123]
    ds_read_b64_tr_b16 v[104:105], v152 offset:28672
    v_mfma_f32_16x16x32_bf16 v[136:139], v[88:91], v[76:79], v[136:139]
    ds_read_b64_tr_b16 v[106:107], v152 offset:30720
    v_mfma_f32_16x16x32_bf16 v[124:127], v[92:95], v[72:75], v[124:127]
    ds_read_b64_tr_b16 v[108:109], v153 offset:28672
    v_mfma_f32_16x16x32_bf16 v[140:143], v[92:95], v[76:79], v[140:143]
    ds_read_b64_tr_b16 v[110:111], v153 offset:30720
    s_waitcnt lgkmcnt(4)
    v_mfma_f32_16x16x32_bf16 v[128:131], v[96:99], v[72:75], v[128:131]
    ds_read_b64_tr_b16 v[112:113], v154 offset:28672
    v_mfma_f32_16x16x32_bf16 v[144:147], v[96:99], v[76:79], v[144:147]
    ds_read_b64_tr_b16 v[114:115], v154 offset:30720
    v_mfma_f32_16x16x32_bf16 v[132:135], v[100:103], v[72:75], v[132:135]
    ds_read_b64_tr_b16 v[116:117], v155 offset:28672
    v_mfma_f32_16x16x32_bf16 v[148:151], v[100:103], v[76:79], v[148:151]
    ds_read_b64_tr_b16 v[118:119], v155 offset:30720
    s_waitcnt vmcnt(0)
    s_waitcnt lgkmcnt(4)
    v_mfma_f32_16x16x32_bf16 v[120:123], v[104:107], v[80:83], v[120:123]
    v_mfma_f32_16x16x32_bf16 v[136:139], v[104:107], v[84:87], v[136:139]
    v_mfma_f32_16x16x32_bf16 v[124:127], v[108:111], v[80:83], v[124:127]
    v_mfma_f32_16x16x32_bf16 v[140:143], v[108:111], v[84:87], v[140:143]
    s_waitcnt lgkmcnt(0)
    v_mfma_f32_16x16x32_bf16 v[128:131], v[112:115], v[80:83], v[128:131]
    v_mfma_f32_16x16x32_bf16 v[144:147], v[112:115], v[84:87], v[144:147]
    v_mfma_f32_16x16x32_bf16 v[132:135], v[116:119], v[80:83], v[132:135]
    v_mfma_f32_16x16x32_bf16 v[148:151], v[116:119], v[84:87], v[148:151]
    s_nop 0
    ds_write_b128 v158, v[136:139] offset:0
    s_nop 0
    ds_write_b128 v158, v[140:143] offset:1024
    s_nop 1
    ds_write_b128 v158, v[144:147] offset:2048
    s_nop 0
    ds_write_b128 v158, v[148:151] offset:3072
    s_waitcnt lgkmcnt(0)
    s_barrier
    ds_read_b128 v[136:139], v159 offset:0
    ds_read_b128 v[140:143], v159 offset:1024
    ds_read_b128 v[144:147], v159 offset:2048
    ds_read_b128 v[148:151], v159 offset:3072
    s_waitcnt lgkmcnt(3)
    v_pk_add_f32 v[120:121], v[120:121], v[136:137] op_sel:[0,0] op_sel_hi:[1,1]
    v_pk_add_f32 v[122:123], v[122:123], v[138:139] op_sel:[0,0] op_sel_hi:[1,1]
    v_cvt_pk_bf16_f32 v16, v120, v121
    v_cvt_pk_bf16_f32 v17, v122, v123
    s_waitcnt lgkmcnt(2)
    v_pk_add_f32 v[124:125], v[124:125], v[140:141] op_sel:[0,0] op_sel_hi:[1,1]
    v_pk_add_f32 v[126:127], v[126:127], v[142:143] op_sel:[0,0] op_sel_hi:[1,1]
    v_cvt_pk_bf16_f32 v18, v124, v125
    v_cvt_pk_bf16_f32 v19, v126, v127
    s_waitcnt lgkmcnt(1)
    v_pk_add_f32 v[128:129], v[128:129], v[144:145] op_sel:[0,0] op_sel_hi:[1,1]
    v_pk_add_f32 v[130:131], v[130:131], v[146:147] op_sel:[0,0] op_sel_hi:[1,1]
    v_cvt_pk_bf16_f32 v20, v128, v129
    v_cvt_pk_bf16_f32 v21, v130, v131
    s_waitcnt lgkmcnt(0)
    v_pk_add_f32 v[132:133], v[132:133], v[148:149] op_sel:[0,0] op_sel_hi:[1,1]
    v_pk_add_f32 v[134:135], v[134:135], v[150:151] op_sel:[0,0] op_sel_hi:[1,1]
    v_cvt_pk_bf16_f32 v22, v132, v133
    v_cvt_pk_bf16_f32 v23, v134, v135
    buffer_store_dwordx4 v[16:19], v10, s[28:31], s80 offen offset:0 sc1
    buffer_store_dwordx4 v[20:23], v10, s[28:31], s80 offen offset:1024 sc1
    v_dot2_f32_bf16 v26, v16, s50, 0
    v_dot2_f32_bf16 v27, v16, v16, 0
    v_dot2_f32_bf16 v28, v17, s50, 0
    v_dot2_f32_bf16 v29, v17, v17, 0
    v_dot2_f32_bf16 v26, v18, s50, v26
    v_dot2_f32_bf16 v27, v18, v18, v27
    v_dot2_f32_bf16 v28, v19, s50, v28
    v_dot2_f32_bf16 v29, v19, v19, v29
    v_dot2_f32_bf16 v26, v20, s50, v26
    v_dot2_f32_bf16 v27, v20, v20, v27
    v_dot2_f32_bf16 v28, v21, s50, v28
    v_dot2_f32_bf16 v29, v21, v21, v29
    v_dot2_f32_bf16 v26, v22, s50, v26
    v_dot2_f32_bf16 v27, v22, v22, v27
    v_dot2_f32_bf16 v28, v23, s50, v28
    v_dot2_f32_bf16 v29, v23, v23, v29
    s_nop 2
    v_pk_add_f32 v[26:27], v[26:27], v[28:29] op_sel:[0,0] op_sel_hi:[1,1]
    v_mov_b32 v28, v26
    v_mov_b32 v29, v27
    s_nop 0
    v_permlane16_swap_b32 v26, v28
    v_permlane16_swap_b32 v27, v29
    v_pk_add_f32 v[26:27], v[26:27], v[28:29] op_sel:[0,0] op_sel_hi:[1,1]
    v_mov_b32 v28, v26
    v_mov_b32 v29, v27
    s_nop 0
    v_permlane32_swap_b32 v26, v28
    v_permlane32_swap_b32 v27, v29
    v_pk_add_f32 v[26:27], v[26:27], v[28:29] op_sel:[0,0] op_sel_hi:[1,1]
    s_mov_b64 exec, s[68:69]
    buffer_store_dwordx2 v[26:27], v160, s[28:31], s81 offen sc1
    s_mov_b64 exec, -1
    v_lshrrev_b32 v4, 2, v2
    v_lshlrev_b32 v5, 2, v3
    v_add_u32 v4, v4, v5
    v_lshrrev_b32 v5, 1, v4
    v_and_b32 v5, 3, v5
    v_mul_u32_u24 v4, 384, v4
    v_and_b32 v6, 3, v1
    v_lshlrev_b32 v6, 3, v6
    v_add_u32 v4, v4, v6
    v_add_u32 v4, 81920, v4
    s_cmp_eq_u32 s38, 0
    s_cselect_b32 s43, 0, 4
    s_mul_i32 s41, s39, 6
    s_add_u32 s41, s41, s43
    s_and_b32 s42, s41, 3
    s_lshr_b32 s41, s41, 2
    s_lshl_b32 s41, s41, 7
    v_xor_b32 v6, s42, v5
    v_lshlrev_b32 v6, 5, v6
    v_add3_u32 v152, v4, v6, s41
    v_add_u32 v176, 6144, v152
    s_cmp_eq_u32 s38, 0
    s_cselect_b32 s43, 1, 5
    s_mul_i32 s41, s39, 6
    s_add_u32 s41, s41, s43
    s_and_b32 s42, s41, 3
    s_lshr_b32 s41, s41, 2
    s_lshl_b32 s41, s41, 7
    v_xor_b32 v6, s42, v5
    v_lshlrev_b32 v6, 5, v6
    v_add3_u32 v153, v4, v6, s41
    v_add_u32 v177, 6144, v153
    s_cmp_eq_u32 s38, 0
    s_cselect_b32 s43, 2, 2
    s_mul_i32 s41, s39, 6
    s_add_u32 s41, s41, s43
    s_and_b32 s42, s41, 3
    s_lshr_b32 s41, s41, 2
    s_lshl_b32 s41, s41, 7
    v_xor_b32 v6, s42, v5
    v_lshlrev_b32 v6, 5, v6
    v_add3_u32 v154, v4, v6, s41
    v_add_u32 v178, 6144, v154
    s_cmp_eq_u32 s38, 0
    s_cselect_b32 s43, 3, 3
    s_mul_i32 s41, s39, 6
    s_add_u32 s41, s41, s43
    s_and_b32 s42, s41, 3
    s_lshr_b32 s41, s41, 2
    s_lshl_b32 s41, s41, 7
    v_xor_b32 v6, s42, v5
    v_lshlrev_b32 v6, 5, v6
    v_add3_u32 v155, v4, v6, s41
    v_add_u32 v179, 6144, v155
    s_cmp_eq_u32 s38, 0
    s_cselect_b32 s43, 4, 0
    s_mul_i32 s41, s39, 6
    s_add_u32 s41, s41, s43
    s_and_b32 s42, s41, 3
    s_lshr_b32 s41, s41, 2
    s_lshl_b32 s41, s41, 7
    v_xor_b32 v6, s42, v5
    v_lshlrev_b32 v6, 5, v6
    v_add3_u32 v156, v4, v6, s41
    v_add_u32 v180, 6144, v156
    s_cmp_eq_u32 s38, 0
    s_cselect_b32 s43, 5, 1
    s_mul_i32 s41, s39, 6
    s_add_u32 s41, s41, s43
    s_and_b32 s42, s41, 3
    s_lshr_b32 s41, s41, 2
    s_lshl_b32 s41, s41, 7
    v_xor_b32 v6, s42, v5
    v_lshlrev_b32 v6, 5, v6
    v_add3_u32 v157, v4, v6, s41
    v_add_u32 v181, 6144, v157
    s_lshl_b32 s41, s38, 15
    v_add_u32 v158, s41, v10
    s_lshl_b32 s41, s38, 11
    s_add_u32 s41, s41, 155648
    v_lshlrev_b32 v4, 3, v2
    v_lshlrev_b32 v5, 8, v3
    v_add3_u32 v182, v4, v5, s41
    s_lshl_b32 s41, s36, 7
    s_add_u32 s41, s41, 159744
    v_lshlrev_b32 v4, 4, v3
    v_add_u32 v183, s41, v4
    s_lshl_b32 s41, s34, 2
    s_lshl_b32 s42, s38, 1
    s_add_u32 s41, s41, s42
    s_mul_i32 s41, s41, 43
    s_mul_i32 s42, s39, 3
    s_add_u32 s41, s41, s42
    s_add_u32 s41, s41, s47
    s_lshl_b32 s41, s41, 10
    s_add_u32 s41, s41, 4194304
    s_add_u32 s43, s35, 1
    s_mul_i32 s43, s43, 43
    s_lshr_b32 s43, s43, 3
    s_sub_u32 s43, s43, s47
    s_cmp_eq_u32 s43, 5
    s_cselect_b32 s43, s39, 0
    s_lshl_b32 s43, s43, 30
    s_cmp_eq_u32 s38, 0
    s_cselect_b32 s42, 0, 2048
    s_add_u32 s72, s41, s42
    s_cmp_eq_u32 s38, 1
    s_cselect_b32 s44, s43, 0
    s_add_u32 s72, s72, s44
    s_add_u32 s75, s72, 44032
    s_cmp_eq_u32 s38, 0
    s_movk_i32 s42, 1024
    s_add_u32 s73, s41, s42
    s_add_u32 s76, s73, 44032
    s_cmp_eq_u32 s38, 0
    s_cselect_b32 s42, 2048, 0
    s_add_u32 s74, s41, s42
    s_cmp_eq_u32 s38, 0
    s_cselect_b32 s44, s43, 0
    s_add_u32 s74, s74, s44
    s_add_u32 s77, s74, 44032
    s_waitcnt vmcnt(0)
    s_movk_i32 s41, 4096
    v_mov_b32 v5, 1
    s_mov_b64 exec, 1
    s_cmp_eq_u32 s53, 0
    s_cbranch_scc1 L_xslow_14
    buffer_store_dword v5, v11, s[28:31], s41 offen
L_xjoin_15:
    s_mov_b64 exec, -1
    s_barrier
    s_barrier
    ds_read_b64 v[164:165], v182 offset:0
    ds_read_b64 v[166:167], v182 offset:128
    ds_read_b64 v[168:169], v182 offset:1024
    ds_read_b64 v[170:171], v182 offset:1152
    ds_read_b128 v[24:27], v158 offset:0
    ds_read_b128 v[28:31], v158 offset:16384
    ds_read_b64_tr_b16 v[40:41], v152 offset:49152
    ds_read_b64_tr_b16 v[42:43], v176 offset:49152
    ds_read_b64_tr_b16 v[44:45], v153 offset:49152
    ds_read_b64_tr_b16 v[46:47], v177 offset:49152
    ds_read_b64_tr_b16 v[48:49], v154 offset:49152
    ds_read_b64_tr_b16 v[50:51], v178 offset:49152
    ds_read_b64_tr_b16 v[52:53], v155 offset:49152
    ds_read_b64_tr_b16 v[54:55], v179 offset:49152
    s_mov_b32 s41, 0xbb000000
    s_mov_b32 s42, 0x3b000000
    s_mov_b32 s43, 0x3727c5ac
    s_waitcnt lgkmcnt(10)
    ds_read_b64_tr_b16 v[56:57], v156 offset:49152
    ds_read_b64_tr_b16 v[58:59], v180 offset:49152
    ds_read_b64_tr_b16 v[60:61], v157 offset:49152
    ds_read_b64_tr_b16 v[62:63], v181 offset:49152
    v_pk_add_f32 v[164:165], v[164:165], v[166:167] op_sel:[0,0] op_sel_hi:[1,1]
    v_pk_add_f32 v[168:169], v[168:169], v[170:171] op_sel:[0,0] op_sel_hi:[1,1]
    v_mov_b32 v166, v164
    v_mov_b32 v167, v165
    v_mov_b32 v170, v168
    v_mov_b32 v171, v169
    v_permlane16_swap_b32 v164, v166
    v_permlane16_swap_b32 v165, v167
    v_permlane16_swap_b32 v168, v170
    v_permlane16_swap_b32 v169, v171
    v_pk_add_f32 v[164:165], v[164:165], v[166:167] op_sel:[0,0] op_sel_hi:[1,1]
    v_pk_add_f32 v[168:169], v[168:169], v[170:171] op_sel:[0,0] op_sel_hi:[1,1]
    v_mov_b32 v166, v164
    v_mov_b32 v167, v165
    v_mov_b32 v170, v168
    v_mov_b32 v171, v169
    v_permlane32_swap_b32 v164, v166
    v_permlane32_swap_b32 v165, v167
    v_permlane32_swap_b32 v168, v170
    v_permlane32_swap_b32 v169, v171
    v_pk_add_f32 v[164:165], v[164:165], v[166:167] op_sel:[0,0] op_sel_hi:[1,1]
    v_pk_add_f32 v[168:169], v[168:169], v[170:171] op_sel:[0,0] op_sel_hi:[1,1]
    v_mul_f32 v160, s41, v164
    v_mul_f32 v166, v160, v160
    v_mul_f32 v161, s41, v168
    v_mul_f32 v170, v161, v161
    v_fma_f32 v166, v165, s42, -v166
    v_max_f32 v166, 0, v166
    v_add_f32 v166, s43, v166
    v_fma_f32 v170, v169, s42, -v170
    v_max_f32 v170, 0, v170
    v_add_f32 v170, s43, v170
    v_rsq_f32 v162, v166
    v_rsq_f32 v163, v170
    s_barrier
    s_waitcnt lgkmcnt(8)
    v_mfma_f32_16x16x32_bf16 v[104:107], v[40:43], v[24:27], 0
    ds_read_b128 v[32:35], v158 offset:1024
    v_mfma_f32_16x16x32_bf16 v[128:131], v[40:43], v[28:31], 0
    ds_read_b128 v[36:39], v158 offset:17408
    v_mfma_f32_16x16x32_bf16 v[208:211], v[40:43], v[192:195], 0
    ds_read_b64_tr_b16 v[64:65], v152 offset:61440
    v_mfma_f32_16x16x32_bf16 v[108:111], v[44:47], v[24:27], 0
    ds_read_b64_tr_b16 v[66:67], v176 offset:61440
    v_mfma_f32_16x16x32_bf16 v[132:135], v[44:47], v[28:31], 0
    ds_read_b64_tr_b16 v[68:69], v153 offset:61440
    v_mfma_f32_16x16x32_bf16 v[212:215], v[44:47], v[192:195], 0
    ds_read_b64_tr_b16 v[70:71], v177 offset:61440
    s_waitcnt lgkmcnt(10)
    v_mfma_f32_16x16x32_bf16 v[112:115], v[48:51], v[24:27], 0
    ds_read_b64_tr_b16 v[72:73], v154 offset:61440
    v_mfma_f32_16x16x32_bf16 v[136:139], v[48:51], v[28:31], 0
    ds_read_b64_tr_b16 v[74:75], v178 offset:61440
    v_mfma_f32_16x16x32_bf16 v[216:219], v[48:51], v[192:195], 0
    ds_read_b64_tr_b16 v[76:77], v155 offset:61440
    v_mfma_f32_16x16x32_bf16 v[116:119], v[52:55], v[24:27], 0
    ds_read_b64_tr_b16 v[78:79], v179 offset:61440
    v_mfma_f32_16x16x32_bf16 v[140:143], v[52:55], v[28:31], 0
    ds_read_b64_tr_b16 v[80:81], v156 offset:61440
    v_mfma_f32_16x16x32_bf16 v[220:223], v[52:55], v[192:195], 0
    ds_read_b64_tr_b16 v[82:83], v180 offset:61440
    s_waitcnt lgkmcnt(12)
    v_mfma_f32_16x16x32_bf16 v[120:123], v[56:59], v[24:27], 0
    ds_read_b64_tr_b16 v[84:85], v157 offset:61440
    v_mfma_f32_16x16x32_bf16 v[144:147], v[56:59], v[28:31], 0
    ds_read_b64_tr_b16 v[86:87], v181 offset:61440
    v_mfma_f32_16x16x32_bf16 v[124:127], v[60:63], v[24:27], 0
    v_mfma_f32_16x16x32_bf16 v[148:151], v[60:63], v[28:31], 0
    s_barrier
    s_waitcnt lgkmcnt(8)
    v_mfma_f32_16x16x32_bf16 v[104:107], v[64:67], v[32:35], v[104:107]
    ds_read_b128 v[24:27], v158 offset:2048
    v_mfma_f32_16x16x32_bf16 v[128:131], v[64:67], v[36:39], v[128:131]
    ds_read_b128 v[28:31], v158 offset:18432
    v_mfma_f32_16x16x32_bf16 v[208:211], v[64:67], v[192:195], v[208:211]
    ds_read_b64_tr_b16 v[40:41], v152 offset:0
    v_mfma_f32_16x16x32_bf16 v[108:111], v[68:71], v[32:35], v[108:111]
    ds_read_b64_tr_b16 v[42:43], v176 offset:0
    v_mfma_f32_16x16x32_bf16 v[132:135], v[68:71], v[36:39], v[132:135]
    ds_read_b64_tr_b16 v[44:45], v153 offset:0
    v_mfma_f32_16x16x32_bf16 v[212:215], v[68:71], v[192:195], v[212:215]
    ds_read_b64_tr_b16 v[46:47], v177 offset:0
    s_waitcnt lgkmcnt(10)
    v_mfma_f32_16x16x32_bf16 v[112:115], v[72:75], v[32:35], v[112:115]
    ds_read_b64_tr_b16 v[48:49], v154 offset:0
    v_mfma_f32_16x16x32_bf16 v[136:139], v[72:75], v[36:39], v[136:139]
    ds_read_b64_tr_b16 v[50:51], v178 offset:0
    v_mfma_f32_16x16x32_bf16 v[216:219], v[72:75], v[192:195], v[216:219]
    ds_read_b64_tr_b16 v[52:53], v155 offset:0
    v_mfma_f32_16x16x32_bf16 v[116:119], v[76:79], v[32:35], v[116:119]
    ds_read_b64_tr_b16 v[54:55], v179 offset:0
    v_mfma_f32_16x16x32_bf16 v[140:143], v[76:79], v[36:39], v[140:143]
    ds_read_b64_tr_b16 v[56:57], v156 offset:0
    v_mfma_f32_16x16x32_bf16 v[220:223], v[76:79], v[192:195], v[220:223]
    ds_read_b64_tr_b16 v[58:59], v180 offset:0
    s_waitcnt lgkmcnt(12)
    v_mfma_f32_16x16x32_bf16 v[120:123], v[80:83], v[32:35], v[120:123]
    ds_read_b64_tr_b16 v[60:61], v157 offset:0
    v_mfma_f32_16x16x32_bf16 v[144:147], v[80:83], v[36:39], v[144:147]
    ds_read_b64_tr_b16 v[62:63], v181 offset:0
    v_mfma_f32_16x16x32_bf16 v[124:127], v[84:87], v[32:35], v[124:127]
    v_mfma_f32_16x16x32_bf16 v[148:151], v[84:87], v[36:39], v[148:151]
    s_barrier
    s_waitcnt lgkmcnt(8)
    v_mfma_f32_16x16x32_bf16 v[104:107], v[40:43], v[24:27], v[104:107]
    ds_read_b128 v[32:35], v158 offset:3072
    v_mfma_f32_16x16x32_bf16 v[128:131], v[40:43], v[28:31], v[128:131]
    ds_read_b128 v[36:39], v158 offset:19456
    v_mfma_f32_16x16x32_bf16 v[208:211], v[40:43], v[192:195], v[208:211]
    ds_read_b64_tr_b16 v[64:65], v152 offset:12288
    v_mfma_f32_16x16x32_bf16 v[108:111], v[44:47], v[24:27], v[108:111]
    ds_read_b64_tr_b16 v[66:67], v176 offset:12288
    v_mfma_f32_16x16x32_bf16 v[132:135], v[44:47], v[28:31], v[132:135]
    ds_read_b64_tr_b16 v[68:69], v153 offset:12288
    v_mfma_f32_16x16x32_bf16 v[212:215], v[44:47], v[192:195], v[212:215]
    ds_read_b64_tr_b16 v[70:71], v177 offset:12288
    s_waitcnt lgkmcnt(10)
    v_mfma_f32_16x16x32_bf16 v[112:115], v[48:51], v[24:27], v[112:115]
    ds_read_b64_tr_b16 v[72:73], v154 offset:12288
    v_mfma_f32_16x16x32_bf16 v[136:139], v[48:51], v[28:31], v[136:139]
    ds_read_b64_tr_b16 v[74:75], v178 offset:12288
    v_mfma_f32_16x16x32_bf16 v[216:219], v[48:51], v[192:195], v[216:219]
    ds_read_b64_tr_b16 v[76:77], v155 offset:12288
    v_mfma_f32_16x16x32_bf16 v[116:119], v[52:55], v[24:27], v[116:119]
    ds_read_b64_tr_b16 v[78:79], v179 offset:12288
    v_mfma_f32_16x16x32_bf16 v[140:143], v[52:55], v[28:31], v[140:143]
    ds_read_b64_tr_b16 v[80:81], v156 offset:12288
    v_mfma_f32_16x16x32_bf16 v[220:223], v[52:55], v[192:195], v[220:223]
    ds_read_b64_tr_b16 v[82:83], v180 offset:12288
    s_waitcnt lgkmcnt(12)
    v_mfma_f32_16x16x32_bf16 v[120:123], v[56:59], v[24:27], v[120:123]
    ds_read_b64_tr_b16 v[84:85], v157 offset:12288
    v_mfma_f32_16x16x32_bf16 v[144:147], v[56:59], v[28:31], v[144:147]
    ds_read_b64_tr_b16 v[86:87], v181 offset:12288
    v_mfma_f32_16x16x32_bf16 v[124:127], v[60:63], v[24:27], v[124:127]
    v_mfma_f32_16x16x32_bf16 v[148:151], v[60:63], v[28:31], v[148:151]
    s_barrier
    s_waitcnt lgkmcnt(8)
    v_mfma_f32_16x16x32_bf16 v[104:107], v[64:67], v[32:35], v[104:107]
    ds_read_b128 v[24:27], v158 offset:4096
    v_mfma_f32_16x16x32_bf16 v[128:131], v[64:67], v[36:39], v[128:131]
    ds_read_b128 v[28:31], v158 offset:20480
    v_mfma_f32_16x16x32_bf16 v[208:211], v[64:67], v[192:195], v[208:211]
    ds_read_b64_tr_b16 v[40:41], v152 offset:24576
    v_mfma_f32_16x16x32_bf16 v[108:111], v[68:71], v[32:35], v[108:111]
    ds_read_b64_tr_b16 v[42:43], v176 offset:24576
    v_mfma_f32_16x16x32_bf16 v[132:135], v[68:71], v[36:39], v[132:135]
    ds_read_b64_tr_b16 v[44:45], v153 offset:24576
    v_mfma_f32_16x16x32_bf16 v[212:215], v[68:71], v[192:195], v[212:215]
    ds_read_b64_tr_b16 v[46:47], v177 offset:24576
    s_waitcnt lgkmcnt(10)
    v_mfma_f32_16x16x32_bf16 v[112:115], v[72:75], v[32:35], v[112:115]
    ds_read_b64_tr_b16 v[48:49], v154 offset:24576
    v_mfma_f32_16x16x32_bf16 v[136:139], v[72:75], v[36:39], v[136:139]
    ds_read_b64_tr_b16 v[50:51], v178 offset:24576
    v_mfma_f32_16x16x32_bf16 v[216:219], v[72:75], v[192:195], v[216:219]
    ds_read_b64_tr_b16 v[52:53], v155 offset:24576
    v_mfma_f32_16x16x32_bf16 v[116:119], v[76:79], v[32:35], v[116:119]
    ds_read_b64_tr_b16 v[54:55], v179 offset:24576
    v_mfma_f32_16x16x32_bf16 v[140:143], v[76:79], v[36:39], v[140:143]
    ds_read_b64_tr_b16 v[56:57], v156 offset:24576
    v_mfma_f32_16x16x32_bf16 v[220:223], v[76:79], v[192:195], v[220:223]
    ds_read_b64_tr_b16 v[58:59], v180 offset:24576
    s_waitcnt lgkmcnt(12)
    v_mfma_f32_16x16x32_bf16 v[120:123], v[80:83], v[32:35], v[120:123]
    ds_read_b64_tr_b16 v[60:61], v157 offset:24576
    v_mfma_f32_16x16x32_bf16 v[144:147], v[80:83], v[36:39], v[144:147]
    ds_read_b64_tr_b16 v[62:63], v181 offset:24576
    v_mfma_f32_16x16x32_bf16 v[124:127], v[84:87], v[32:35], v[124:127]
    v_mfma_f32_16x16x32_bf16 v[148:151], v[84:87], v[36:39], v[148:151]
    s_barrier
    s_waitcnt lgkmcnt(8)
    v_mfma_f32_16x16x32_bf16 v[104:107], v[40:43], v[24:27], v[104:107]
    ds_read_b128 v[32:35], v158 offset:5120
    v_mfma_f32_16x16x32_bf16 v[128:131], v[40:43], v[28:31], v[128:131]
    ds_read_b128 v[36:39], v158 offset:21504
    v_mfma_f32_16x16x32_bf16 v[208:211], v[40:43], v[192:195], v[208:211]
    ds_read_b64_tr_b16 v[64:65], v152 offset:36864
    v_mfma_f32_16x16x32_bf16 v[108:111], v[44:47], v[24:27], v[108:111]
    ds_read_b64_tr_b16 v[66:67], v176 offset:36864
    v_mfma_f32_16x16x32_bf16 v[132:135], v[44:47], v[28:31], v[132:135]
    ds_read_b64_tr_b16 v[68:69], v153 offset:36864
    v_mfma_f32_16x16x32_bf16 v[212:215], v[44:47], v[192:195], v[212:215]
    ds_read_b64_tr_b16 v[70:71], v177 offset:36864
    s_waitcnt lgkmcnt(10)
    v_mfma_f32_16x16x32_bf16 v[112:115], v[48:51], v[24:27], v[112:115]
    ds_read_b64_tr_b16 v[72:73], v154 offset:36864
    v_mfma_f32_16x16x32_bf16 v[136:139], v[48:51], v[28:31], v[136:139]
    ds_read_b64_tr_b16 v[74:75], v178 offset:36864
    v_mfma_f32_16x16x32_bf16 v[216:219], v[48:51], v[192:195], v[216:219]
    ds_read_b64_tr_b16 v[76:77], v155 offset:36864
    v_mfma_f32_16x16x32_bf16 v[116:119], v[52:55], v[24:27], v[116:119]
    ds_read_b64_tr_b16 v[78:79], v179 offset:36864
    v_mfma_f32_16x16x32_bf16 v[140:143], v[52:55], v[28:31], v[140:143]
    ds_read_b64_tr_b16 v[80:81], v156 offset:36864
    v_mfma_f32_16x16x32_bf16 v[220:223], v[52:55], v[192:195], v[220:223]
    ds_read_b64_tr_b16 v[82:83], v180 offset:36864
    s_waitcnt lgkmcnt(12)
    v_mfma_f32_16x16x32_bf16 v[120:123], v[56:59], v[24:27], v[120:123]
    ds_read_b64_tr_b16 v[84:85], v157 offset:36864
    v_mfma_f32_16x16x32_bf16 v[144:147], v[56:59], v[28:31], v[144:147]
    ds_read_b64_tr_b16 v[86:87], v181 offset:36864
    v_mfma_f32_16x16x32_bf16 v[124:127], v[60:63], v[24:27], v[124:127]
    v_mfma_f32_16x16x32_bf16 v[148:151], v[60:63], v[28:31], v[148:151]
    s_barrier
    s_waitcnt lgkmcnt(8)
    v_mfma_f32_16x16x32_bf16 v[104:107], v[64:67], v[32:35], v[104:107]
    ds_read_b128 v[24:27], v158 offset:6144
    v_mfma_f32_16x16x32_bf16 v[128:131], v[64:67], v[36:39], v[128:131]
    ds_read_b128 v[28:31], v158 offset:22528
    v_mfma_f32_16x16x32_bf16 v[208:211], v[64:67], v[192:195], v[208:211]
    ds_read_b64_tr_b16 v[40:41], v152 offset:49152
    v_mfma_f32_16x16x32_bf16 v[108:111], v[68:71], v[32:35], v[108:111]
    ds_read_b64_tr_b16 v[42:43], v176 offset:49152
    v_mfma_f32_16x16x32_bf16 v[132:135], v[68:71], v[36:39], v[132:135]
    ds_read_b64_tr_b16 v[44:45], v153 offset:49152
    v_mfma_f32_16x16x32_bf16 v[212:215], v[68:71], v[192:195], v[212:215]
    ds_read_b64_tr_b16 v[46:47], v177 offset:49152
    s_waitcnt lgkmcnt(10)
    v_mfma_f32_16x16x32_bf16 v[112:115], v[72:75], v[32:35], v[112:115]
    ds_read_b64_tr_b16 v[48:49], v154 offset:49152
    v_mfma_f32_16x16x32_bf16 v[136:139], v[72:75], v[36:39], v[136:139]
    ds_read_b64_tr_b16 v[50:51], v178 offset:49152
    v_mfma_f32_16x16x32_bf16 v[216:219], v[72:75], v[192:195], v[216:219]
    ds_read_b64_tr_b16 v[52:53], v155 offset:49152
    v_mfma_f32_16x16x32_bf16 v[116:119], v[76:79], v[32:35], v[116:119]
    ds_read_b64_tr_b16 v[54:55], v179 offset:49152
    v_mfma_f32_16x16x32_bf16 v[140:143], v[76:79], v[36:39], v[140:143]
    ds_read_b64_tr_b16 v[56:57], v156 offset:49152
    v_mfma_f32_16x16x32_bf16 v[220:223], v[76:79], v[192:195], v[220:223]
    ds_read_b64_tr_b16 v[58:59], v180 offset:49152
    s_waitcnt lgkmcnt(12)
    v_mfma_f32_16x16x32_bf16 v[120:123], v[80:83], v[32:35], v[120:123]
    ds_read_b64_tr_b16 v[60:61], v157 offset:49152
    v_mfma_f32_16x16x32_bf16 v[144:147], v[80:83], v[36:39], v[144:147]
    ds_read_b64_tr_b16 v[62:63], v181 offset:49152
    v_mfma_f32_16x16x32_bf16 v[124:127], v[84:87], v[32:35], v[124:127]
    v_mfma_f32_16x16x32_bf16 v[148:151], v[84:87], v[36:39], v[148:151]
    s_barrier
    s_waitcnt lgkmcnt(8)
    v_mfma_f32_16x16x32_bf16 v[104:107], v[40:43], v[24:27], v[104:107]
    ds_read_b128 v[32:35], v158 offset:7168
    v_mfma_f32_16x16x32_bf16 v[128:131], v[40:43], v[28:31], v[128:131]
    ds_read_b128 v[36:39], v158 offset:23552
    v_mfma_f32_16x16x32_bf16 v[208:211], v[40:43], v[192:195], v[208:211]
    ds_read_b64_tr_b16 v[64:65], v152 offset:61440
    v_mfma_f32_16x16x32_bf16 v[108:111], v[44:47], v[24:27], v[108:111]
    ds_read_b64_tr_b16 v[66:67], v176 offset:61440
    v_mfma_f32_16x16x32_bf16 v[132:135], v[44:47], v[28:31], v[132:135]
    ds_read_b64_tr_b16 v[68:69], v153 offset:61440
    v_mfma_f32_16x16x32_bf16 v[212:215], v[44:47], v[192:195], v[212:215]
    ds_read_b64_tr_b16 v[70:71], v177 offset:61440
    s_waitcnt lgkmcnt(10)
    v_mfma_f32_16x16x32_bf16 v[112:115], v[48:51], v[24:27], v[112:115]
    ds_read_b64_tr_b16 v[72:73], v154 offset:61440
    v_mfma_f32_16x16x32_bf16 v[136:139], v[48:51], v[28:31], v[136:139]
    ds_read_b64_tr_b16 v[74:75], v178 offset:61440
    v_mfma_f32_16x16x32_bf16 v[216:219], v[48:51], v[192:195], v[216:219]
    ds_read_b64_tr_b16 v[76:77], v155 offset:61440
    v_mfma_f32_16x16x32_bf16 v[116:119], v[52:55], v[24:27], v[116:119]
    ds_read_b64_tr_b16 v[78:79], v179 offset:61440
    v_mfma_f32_16x16x32_bf16 v[140:143], v[52:55], v[28:31], v[140:143]
    ds_read_b64_tr_b16 v[80:81], v156 offset:61440
    v_mfma_f32_16x16x32_bf16 v[220:223], v[52:55], v[192:195], v[220:223]
    ds_read_b64_tr_b16 v[82:83], v180 offset:61440
    s_waitcnt lgkmcnt(12)
    v_mfma_f32_16x16x32_bf16 v[120:123], v[56:59], v[24:27], v[120:123]
    ds_read_b64_tr_b16 v[84:85], v157 offset:61440
    v_mfma_f32_16x16x32_bf16 v[144:147], v[56:59], v[28:31], v[144:147]
    ds_read_b64_tr_b16 v[86:87], v181 offset:61440
    v_mfma_f32_16x16x32_bf16 v[124:127], v[60:63], v[24:27], v[124:127]
    v_mfma_f32_16x16x32_bf16 v[148:151], v[60:63], v[28:31], v[148:151]
    s_barrier
    s_waitcnt lgkmcnt(8)
    v_mfma_f32_16x16x32_bf16 v[104:107], v[64:67], v[32:35], v[104:107]
    ds_read_b128 v[24:27], v158 offset:8192
    v_mfma_f32_16x16x32_bf16 v[128:131], v[64:67], v[36:39], v[128:131]
    ds_read_b128 v[28:31], v158 offset:24576
    v_mfma_f32_16x16x32_bf16 v[208:211], v[64:67], v[192:195], v[208:211]
    ds_read_b64_tr_b16 v[40:41], v152 offset:0
    v_mfma_f32_16x16x32_bf16 v[108:111], v[68:71], v[32:35], v[108:111]
    ds_read_b64_tr_b16 v[42:43], v176 offset:0
    v_mfma_f32_16x16x32_bf16 v[132:135], v[68:71], v[36:39], v[132:135]
    ds_read_b64_tr_b16 v[44:45], v153 offset:0
    v_mfma_f32_16x16x32_bf16 v[212:215], v[68:71], v[192:195], v[212:215]
    ds_read_b64_tr_b16 v[46:47], v177 offset:0
    s_waitcnt lgkmcnt(10)
    v_mfma_f32_16x16x32_bf16 v[112:115], v[72:75], v[32:35], v[112:115]
    ds_read_b64_tr_b16 v[48:49], v154 offset:0
    v_mfma_f32_16x16x32_bf16 v[136:139], v[72:75], v[36:39], v[136:139]
    ds_read_b64_tr_b16 v[50:51], v178 offset:0
    v_mfma_f32_16x16x32_bf16 v[216:219], v[72:75], v[192:195], v[216:219]
    ds_read_b64_tr_b16 v[52:53], v155 offset:0
    v_mfma_f32_16x16x32_bf16 v[116:119], v[76:79], v[32:35], v[116:119]
    ds_read_b64_tr_b16 v[54:55], v179 offset:0
    v_mfma_f32_16x16x32_bf16 v[140:143], v[76:79], v[36:39], v[140:143]
    ds_read_b64_tr_b16 v[56:57], v156 offset:0
    v_mfma_f32_16x16x32_bf16 v[220:223], v[76:79], v[192:195], v[220:223]
    ds_read_b64_tr_b16 v[58:59], v180 offset:0
    s_waitcnt lgkmcnt(12)
    v_mfma_f32_16x16x32_bf16 v[120:123], v[80:83], v[32:35], v[120:123]
    ds_read_b64_tr_b16 v[60:61], v157 offset:0
    v_mfma_f32_16x16x32_bf16 v[144:147], v[80:83], v[36:39], v[144:147]
    ds_read_b64_tr_b16 v[62:63], v181 offset:0
    v_mfma_f32_16x16x32_bf16 v[124:127], v[84:87], v[32:35], v[124:127]
    v_mfma_f32_16x16x32_bf16 v[148:151], v[84:87], v[36:39], v[148:151]
    s_barrier
    s_waitcnt lgkmcnt(8)
    v_mfma_f32_16x16x32_bf16 v[104:107], v[40:43], v[24:27], v[104:107]
    ds_read_b128 v[32:35], v158 offset:9216
    v_mfma_f32_16x16x32_bf16 v[128:131], v[40:43], v[28:31], v[128:131]
    ds_read_b128 v[36:39], v158 offset:25600
    v_mfma_f32_16x16x32_bf16 v[208:211], v[40:43], v[192:195], v[208:211]
    ds_read_b64_tr_b16 v[64:65], v152 offset:12288
    v_mfma_f32_16x16x32_bf16 v[108:111], v[44:47], v[24:27], v[108:111]
    ds_read_b64_tr_b16 v[66:67], v176 offset:12288
    v_mfma_f32_16x16x32_bf16 v[132:135], v[44:47], v[28:31], v[132:135]
    ds_read_b64_tr_b16 v[68:69], v153 offset:12288
    v_mfma_f32_16x16x32_bf16 v[212:215], v[44:47], v[192:195], v[212:215]
    ds_read_b64_tr_b16 v[70:71], v177 offset:12288
    s_waitcnt lgkmcnt(10)
    v_mfma_f32_16x16x32_bf16 v[112:115], v[48:51], v[24:27], v[112:115]
    ds_read_b64_tr_b16 v[72:73], v154 offset:12288
    v_mfma_f32_16x16x32_bf16 v[136:139], v[48:51], v[28:31], v[136:139]
    ds_read_b64_tr_b16 v[74:75], v178 offset:12288
    v_mfma_f32_16x16x32_bf16 v[216:219], v[48:51], v[192:195], v[216:219]
    ds_read_b64_tr_b16 v[76:77], v155 offset:12288
    v_mfma_f32_16x16x32_bf16 v[116:119], v[52:55], v[24:27], v[116:119]
    ds_read_b64_tr_b16 v[78:79], v179 offset:12288
    v_mfma_f32_16x16x32_bf16 v[140:143], v[52:55], v[28:31], v[140:143]
    ds_read_b64_tr_b16 v[80:81], v156 offset:12288
    v_mfma_f32_16x16x32_bf16 v[220:223], v[52:55], v[192:195], v[220:223]
    ds_read_b64_tr_b16 v[82:83], v180 offset:12288
    s_waitcnt lgkmcnt(12)
    v_mfma_f32_16x16x32_bf16 v[120:123], v[56:59], v[24:27], v[120:123]
    ds_read_b64_tr_b16 v[84:85], v157 offset:12288
    v_mfma_f32_16x16x32_bf16 v[144:147], v[56:59], v[28:31], v[144:147]
    ds_read_b64_tr_b16 v[86:87], v181 offset:12288
    v_mfma_f32_16x16x32_bf16 v[124:127], v[60:63], v[24:27], v[124:127]
    v_mfma_f32_16x16x32_bf16 v[148:151], v[60:63], v[28:31], v[148:151]
    s_barrier
    s_waitcnt lgkmcnt(8)
    v_mfma_f32_16x16x32_bf16 v[104:107], v[64:67], v[32:35], v[104:107]
    ds_read_b128 v[24:27], v158 offset:10240
    v_mfma_f32_16x16x32_bf16 v[128:131], v[64:67], v[36:39], v[128:131]
    ds_read_b128 v[28:31], v158 offset:26624
    v_mfma_f32_16x16x32_bf16 v[208:211], v[64:67], v[192:195], v[208:211]
    ds_read_b64_tr_b16 v[40:41], v152 offset:24576
    v_mfma_f32_16x16x32_bf16 v[108:111], v[68:71], v[32:35], v[108:111]
    ds_read_b64_tr_b16 v[42:43], v176 offset:24576
    v_mfma_f32_16x16x32_bf16 v[132:135], v[68:71], v[36:39], v[132:135]
    ds_read_b64_tr_b16 v[44:45], v153 offset:24576
    v_mfma_f32_16x16x32_bf16 v[212:215], v[68:71], v[192:195], v[212:215]
    ds_read_b64_tr_b16 v[46:47], v177 offset:24576
    s_waitcnt lgkmcnt(10)
    v_mfma_f32_16x16x32_bf16 v[112:115], v[72:75], v[32:35], v[112:115]
    ds_read_b64_tr_b16 v[48:49], v154 offset:24576
    v_mfma_f32_16x16x32_bf16 v[136:139], v[72:75], v[36:39], v[136:139]
    ds_read_b64_tr_b16 v[50:51], v178 offset:24576
    v_mfma_f32_16x16x32_bf16 v[216:219], v[72:75], v[192:195], v[216:219]
    ds_read_b64_tr_b16 v[52:53], v155 offset:24576
    v_mfma_f32_16x16x32_bf16 v[116:119], v[76:79], v[32:35], v[116:119]
    ds_read_b64_tr_b16 v[54:55], v179 offset:24576
    v_mfma_f32_16x16x32_bf16 v[140:143], v[76:79], v[36:39], v[140:143]
    ds_read_b64_tr_b16 v[56:57], v156 offset:24576
    v_mfma_f32_16x16x32_bf16 v[220:223], v[76:79], v[192:195], v[220:223]
    ds_read_b64_tr_b16 v[58:59], v180 offset:24576
    s_waitcnt lgkmcnt(12)
    v_mfma_f32_16x16x32_bf16 v[120:123], v[80:83], v[32:35], v[120:123]
    ds_read_b64_tr_b16 v[60:61], v157 offset:24576
    v_mfma_f32_16x16x32_bf16 v[144:147], v[80:83], v[36:39], v[144:147]
    ds_read_b64_tr_b16 v[62:63], v181 offset:24576
    v_mfma_f32_16x16x32_bf16 v[124:127], v[84:87], v[32:35], v[124:127]
    v_mfma_f32_16x16x32_bf16 v[148:151], v[84:87], v[36:39], v[148:151]
    s_barrier
    s_waitcnt lgkmcnt(8)
    v_mfma_f32_16x16x32_bf16 v[104:107], v[40:43], v[24:27], v[104:107]
    ds_read_b128 v[32:35], v158 offset:11264
    v_mfma_f32_16x16x32_bf16 v[128:131], v[40:43], v[28:31], v[128:131]
    ds_read_b128 v[36:39], v158 offset:27648
    v_mfma_f32_16x16x32_bf16 v[208:211], v[40:43], v[192:195], v[208:211]
    ds_read_b64_tr_b16 v[64:65], v152 offset:36864
    v_mfma_f32_16x16x32_bf16 v[108:111], v[44:47], v[24:27], v[108:111]
    ds_read_b64_tr_b16 v[66:67], v176 offset:36864
    v_mfma_f32_16x16x32_bf16 v[132:135], v[44:47], v[28:31], v[132:135]
    ds_read_b64_tr_b16 v[68:69], v153 offset:36864
    v_mfma_f32_16x16x32_bf16 v[212:215], v[44:47], v[192:195], v[212:215]
    ds_read_b64_tr_b16 v[70:71], v177 offset:36864
    s_waitcnt lgkmcnt(10)
    v_mfma_f32_16x16x32_bf16 v[112:115], v[48:51], v[24:27], v[112:115]
    ds_read_b64_tr_b16 v[72:73], v154 offset:36864
    v_mfma_f32_16x16x32_bf16 v[136:139], v[48:51], v[28:31], v[136:139]
    ds_read_b64_tr_b16 v[74:75], v178 offset:36864
    v_mfma_f32_16x16x32_bf16 v[216:219], v[48:51], v[192:195], v[216:219]
    ds_read_b64_tr_b16 v[76:77], v155 offset:36864
    v_mfma_f32_16x16x32_bf16 v[116:119], v[52:55], v[24:27], v[116:119]
    ds_read_b64_tr_b16 v[78:79], v179 offset:36864
    v_mfma_f32_16x16x32_bf16 v[140:143], v[52:55], v[28:31], v[140:143]
    ds_read_b64_tr_b16 v[80:81], v156 offset:36864
    v_mfma_f32_16x16x32_bf16 v[220:223], v[52:55], v[192:195], v[220:223]
    ds_read_b64_tr_b16 v[82:83], v180 offset:36864
    s_waitcnt lgkmcnt(12)
    v_mfma_f32_16x16x32_bf16 v[120:123], v[56:59], v[24:27], v[120:123]
    ds_read_b64_tr_b16 v[84:85], v157 offset:36864
    v_mfma_f32_16x16x32_bf16 v[144:147], v[56:59], v[28:31], v[144:147]
    ds_read_b64_tr_b16 v[86:87], v181 offset:36864
    v_mfma_f32_16x16x32_bf16 v[124:127], v[60:63], v[24:27], v[124:127]
    v_mfma_f32_16x16x32_bf16 v[148:151], v[60:63], v[28:31], v[148:151]
    s_barrier
    s_waitcnt lgkmcnt(8)
    v_mfma_f32_16x16x32_bf16 v[104:107], v[64:67], v[32:35], v[104:107]
    ds_read_b128 v[24:27], v158 offset:12288
    v_mfma_f32_16x16x32_bf16 v[128:131], v[64:67], v[36:39], v[128:131]
    ds_read_b128 v[28:31], v158 offset:28672
    v_mfma_f32_16x16x32_bf16 v[208:211], v[64:67], v[192:195], v[208:211]
    ds_read_b64_tr_b16 v[40:41], v152 offset:49152
    v_mfma_f32_16x16x32_bf16 v[108:111], v[68:71], v[32:35], v[108:111]
    ds_read_b64_tr_b16 v[42:43], v176 offset:49152
    v_mfma_f32_16x16x32_bf16 v[132:135], v[68:71], v[36:39], v[132:135]
    ds_read_b64_tr_b16 v[44:45], v153 offset:49152
    v_mfma_f32_16x16x32_bf16 v[212:215], v[68:71], v[192:195], v[212:215]
    ds_read_b64_tr_b16 v[46:47], v177 offset:49152
    s_waitcnt lgkmcnt(10)
    v_mfma_f32_16x16x32_bf16 v[112:115], v[72:75], v[32:35], v[112:115]
    ds_read_b64_tr_b16 v[48:49], v154 offset:49152
    v_mfma_f32_16x16x32_bf16 v[136:139], v[72:75], v[36:39], v[136:139]
    ds_read_b64_tr_b16 v[50:51], v178 offset:49152
    v_mfma_f32_16x16x32_bf16 v[216:219], v[72:75], v[192:195], v[216:219]
    ds_read_b64_tr_b16 v[52:53], v155 offset:49152
    v_mfma_f32_16x16x32_bf16 v[116:119], v[76:79], v[32:35], v[116:119]
    ds_read_b64_tr_b16 v[54:55], v179 offset:49152
    v_mfma_f32_16x16x32_bf16 v[140:143], v[76:79], v[36:39], v[140:143]
    ds_read_b64_tr_b16 v[56:57], v156 offset:49152
    v_mfma_f32_16x16x32_bf16 v[220:223], v[76:79], v[192:195], v[220:223]
    ds_read_b64_tr_b16 v[58:59], v180 offset:49152
    s_waitcnt lgkmcnt(12)
    v_mfma_f32_16x16x32_bf16 v[120:123], v[80:83], v[32:35], v[120:123]
    ds_read_b64_tr_b16 v[60:61], v157 offset:49152
    v_mfma_f32_16x16x32_bf16 v[144:147], v[80:83], v[36:39], v[144:147]
    ds_read_b64_tr_b16 v[62:63], v181 offset:49152
    v_mfma_f32_16x16x32_bf16 v[124:127], v[84:87], v[32:35], v[124:127]
    v_mfma_f32_16x16x32_bf16 v[148:151], v[84:87], v[36:39], v[148:151]
    s_barrier
    s_waitcnt lgkmcnt(8)
    v_mfma_f32_16x16x32_bf16 v[104:107], v[40:43], v[24:27], v[104:107]
    ds_read_b128 v[32:35], v158 offset:13312
    v_mfma_f32_16x16x32_bf16 v[128:131], v[40:43], v[28:31], v[128:131]
    ds_read_b128 v[36:39], v158 offset:29696
    v_mfma_f32_16x16x32_bf16 v[208:211], v[40:43], v[192:195], v[208:211]
    ds_read_b64_tr_b16 v[64:65], v152 offset:61440
    v_mfma_f32_16x16x32_bf16 v[108:111], v[44:47], v[24:27], v[108:111]
    ds_read_b64_tr_b16 v[66:67], v176 offset:61440
    v_mfma_f32_16x16x32_bf16 v[132:135], v[44:47], v[28:31], v[132:135]
    ds_read_b64_tr_b16 v[68:69], v153 offset:61440
    v_mfma_f32_16x16x32_bf16 v[212:215], v[44:47], v[192:195], v[212:215]
    ds_read_b64_tr_b16 v[70:71], v177 offset:61440
    s_waitcnt lgkmcnt(10)
    v_mfma_f32_16x16x32_bf16 v[112:115], v[48:51], v[24:27], v[112:115]
    ds_read_b64_tr_b16 v[72:73], v154 offset:61440
    v_mfma_f32_16x16x32_bf16 v[136:139], v[48:51], v[28:31], v[136:139]
    ds_read_b64_tr_b16 v[74:75], v178 offset:61440
    v_mfma_f32_16x16x32_bf16 v[216:219], v[48:51], v[192:195], v[216:219]
    ds_read_b64_tr_b16 v[76:77], v155 offset:61440
    v_mfma_f32_16x16x32_bf16 v[116:119], v[52:55], v[24:27], v[116:119]
    ds_read_b64_tr_b16 v[78:79], v179 offset:61440
    v_mfma_f32_16x16x32_bf16 v[140:143], v[52:55], v[28:31], v[140:143]
    ds_read_b64_tr_b16 v[80:81], v156 offset:61440
    v_mfma_f32_16x16x32_bf16 v[220:223], v[52:55], v[192:195], v[220:223]
    ds_read_b64_tr_b16 v[82:83], v180 offset:61440
    s_waitcnt lgkmcnt(12)
    v_mfma_f32_16x16x32_bf16 v[120:123], v[56:59], v[24:27], v[120:123]
    ds_read_b64_tr_b16 v[84:85], v157 offset:61440
    v_mfma_f32_16x16x32_bf16 v[144:147], v[56:59], v[28:31], v[144:147]
    ds_read_b64_tr_b16 v[86:87], v181 offset:61440
    v_mfma_f32_16x16x32_bf16 v[124:127], v[60:63], v[24:27], v[124:127]
    v_mfma_f32_16x16x32_bf16 v[148:151], v[60:63], v[28:31], v[148:151]
    s_barrier
    s_waitcnt lgkmcnt(8)
    v_mfma_f32_16x16x32_bf16 v[104:107], v[64:67], v[32:35], v[104:107]
    ds_read_b128 v[24:27], v158 offset:14336
    v_mfma_f32_16x16x32_bf16 v[128:131], v[64:67], v[36:39], v[128:131]
    ds_read_b128 v[28:31], v158 offset:30720
    v_mfma_f32_16x16x32_bf16 v[208:211], v[64:67], v[192:195], v[208:211]
    ds_read_b64_tr_b16 v[40:41], v152 offset:0
    v_mfma_f32_16x16x32_bf16 v[108:111], v[68:71], v[32:35], v[108:111]
    ds_read_b64_tr_b16 v[42:43], v176 offset:0
    v_mfma_f32_16x16x32_bf16 v[132:135], v[68:71], v[36:39], v[132:135]
    ds_read_b64_tr_b16 v[44:45], v153 offset:0
    v_mfma_f32_16x16x32_bf16 v[212:215], v[68:71], v[192:195], v[212:215]
    ds_read_b64_tr_b16 v[46:47], v177 offset:0
    s_waitcnt lgkmcnt(10)
    v_mfma_f32_16x16x32_bf16 v[112:115], v[72:75], v[32:35], v[112:115]
    ds_read_b64_tr_b16 v[48:49], v154 offset:0
    v_mfma_f32_16x16x32_bf16 v[136:139], v[72:75], v[36:39], v[136:139]
    ds_read_b64_tr_b16 v[50:51], v178 offset:0
    v_mfma_f32_16x16x32_bf16 v[216:219], v[72:75], v[192:195], v[216:219]
    ds_read_b64_tr_b16 v[52:53], v155 offset:0
    v_mfma_f32_16x16x32_bf16 v[116:119], v[76:79], v[32:35], v[116:119]
    ds_read_b64_tr_b16 v[54:55], v179 offset:0
    v_mfma_f32_16x16x32_bf16 v[140:143], v[76:79], v[36:39], v[140:143]
    ds_read_b64_tr_b16 v[56:57], v156 offset:0
    v_mfma_f32_16x16x32_bf16 v[220:223], v[76:79], v[192:195], v[220:223]
    ds_read_b64_tr_b16 v[58:59], v180 offset:0
    s_waitcnt lgkmcnt(12)
    v_mfma_f32_16x16x32_bf16 v[120:123], v[80:83], v[32:35], v[120:123]
    ds_read_b64_tr_b16 v[60:61], v157 offset:0
    v_mfma_f32_16x16x32_bf16 v[144:147], v[80:83], v[36:39], v[144:147]
    ds_read_b64_tr_b16 v[62:63], v181 offset:0
    v_mfma_f32_16x16x32_bf16 v[124:127], v[84:87], v[32:35], v[124:127]
    v_mfma_f32_16x16x32_bf16 v[148:151], v[84:87], v[36:39], v[148:151]
    s_barrier
    s_waitcnt lgkmcnt(8)
    v_mfma_f32_16x16x32_bf16 v[104:107], v[40:43], v[24:27], v[104:107]
    ds_read_b128 v[32:35], v158 offset:15360
    v_mfma_f32_16x16x32_bf16 v[128:131], v[40:43], v[28:31], v[128:131]
    ds_read_b128 v[36:39], v158 offset:31744
    v_mfma_f32_16x16x32_bf16 v[208:211], v[40:43], v[192:195], v[208:211]
    ds_read_b64_tr_b16 v[64:65], v152 offset:12288
    v_mfma_f32_16x16x32_bf16 v[108:111], v[44:47], v[24:27], v[108:111]
    ds_read_b64_tr_b16 v[66:67], v176 offset:12288
    v_mfma_f32_16x16x32_bf16 v[132:135], v[44:47], v[28:31], v[132:135]
    ds_read_b64_tr_b16 v[68:69], v153 offset:12288
    v_mfma_f32_16x16x32_bf16 v[212:215], v[44:47], v[192:195], v[212:215]
    ds_read_b64_tr_b16 v[70:71], v177 offset:12288
    s_waitcnt lgkmcnt(10)
    v_mfma_f32_16x16x32_bf16 v[112:115], v[48:51], v[24:27], v[112:115]
    ds_read_b64_tr_b16 v[72:73], v154 offset:12288
    v_mfma_f32_16x16x32_bf16 v[136:139], v[48:51], v[28:31], v[136:139]
    ds_read_b64_tr_b16 v[74:75], v178 offset:12288
    v_mfma_f32_16x16x32_bf16 v[216:219], v[48:51], v[192:195], v[216:219]
    ds_read_b64_tr_b16 v[76:77], v155 offset:12288
    v_mfma_f32_16x16x32_bf16 v[116:119], v[52:55], v[24:27], v[116:119]
    ds_read_b64_tr_b16 v[78:79], v179 offset:12288
    v_mfma_f32_16x16x32_bf16 v[140:143], v[52:55], v[28:31], v[140:143]
    ds_read_b64_tr_b16 v[80:81], v156 offset:12288
    v_mfma_f32_16x16x32_bf16 v[220:223], v[52:55], v[192:195], v[220:223]
    ds_read_b64_tr_b16 v[82:83], v180 offset:12288
    s_waitcnt lgkmcnt(12)
    v_mfma_f32_16x16x32_bf16 v[120:123], v[56:59], v[24:27], v[120:123]
    ds_read_b64_tr_b16 v[84:85], v157 offset:12288
    v_mfma_f32_16x16x32_bf16 v[144:147], v[56:59], v[28:31], v[144:147]
    ds_read_b64_tr_b16 v[86:87], v181 offset:12288
    v_mfma_f32_16x16x32_bf16 v[124:127], v[60:63], v[24:27], v[124:127]
    v_mfma_f32_16x16x32_bf16 v[148:151], v[60:63], v[28:31], v[148:151]
    s_barrier
    s_waitcnt lgkmcnt(8)
    v_mfma_f32_16x16x32_bf16 v[104:107], v[64:67], v[32:35], v[104:107]
    v_mfma_f32_16x16x32_bf16 v[128:131], v[64:67], v[36:39], v[128:131]
    v_mfma_f32_16x16x32_bf16 v[208:211], v[64:67], v[192:195], v[208:211]
    v_mfma_f32_16x16x32_bf16 v[108:111], v[68:71], v[32:35], v[108:111]
    v_mfma_f32_16x16x32_bf16 v[132:135], v[68:71], v[36:39], v[132:135]
    v_mfma_f32_16x16x32_bf16 v[212:215], v[68:71], v[192:195], v[212:215]
    s_waitcnt lgkmcnt(4)
    v_mfma_f32_16x16x32_bf16 v[112:115], v[72:75], v[32:35], v[112:115]
    v_mfma_f32_16x16x32_bf16 v[136:139], v[72:75], v[36:39], v[136:139]
    v_mfma_f32_16x16x32_bf16 v[216:219], v[72:75], v[192:195], v[216:219]
    v_mfma_f32_16x16x32_bf16 v[116:119], v[76:79], v[32:35], v[116:119]
    v_mfma_f32_16x16x32_bf16 v[140:143], v[76:79], v[36:39], v[140:143]
    v_mfma_f32_16x16x32_bf16 v[220:223], v[76:79], v[192:195], v[220:223]
    s_waitcnt lgkmcnt(0)
    v_mfma_f32_16x16x32_bf16 v[120:123], v[80:83], v[32:35], v[120:123]
    v_mfma_f32_16x16x32_bf16 v[144:147], v[80:83], v[36:39], v[144:147]
    v_mfma_f32_16x16x32_bf16 v[124:127], v[84:87], v[32:35], v[124:127]
    v_mfma_f32_16x16x32_bf16 v[148:151], v[84:87], v[36:39], v[148:151]
    s_mov_b32 s78, 0x00010001
    s_mov_b32 s79, 0x00010001
    s_mov_b32 s43, 0xbfb8aa3b
    v_mul_f32 v196, s43, v162
    v_rcp_f32 v198, v162
    v_mul_f32 v197, s43, v163
    v_rcp_f32 v199, v163
    s_mov_b64 exec, s[78:79]
    ds_write_b128 v183, v[208:211] offset:0
    ds_write_b128 v183, v[212:215] offset:64
    s_mov_b64 exec, -1
    s_waitcnt lgkmcnt(0)
    s_barrier
    v_xor_b32 v4, 128, v183
    ds_read_b128 v[224:227], v4 offset:0
    ds_read_b128 v[228:231], v4 offset:64
    v_pk_fma_f32 v[104:105], v[208:209], v[160:161], v[104:105] op_sel:[0,0,0] op_sel_hi:[1,0,1]
    v_pk_fma_f32 v[106:107], v[210:211], v[160:161], v[106:107] op_sel:[0,0,0] op_sel_hi:[1,0,1]
    v_pk_fma_f32 v[108:109], v[212:213], v[160:161], v[108:109] op_sel:[0,0,0] op_sel_hi:[1,0,1]
    v_pk_fma_f32 v[110:111], v[214:215], v[160:161], v[110:111] op_sel:[0,0,0] op_sel_hi:[1,0,1]
    v_pk_mul_f32 v[168:169], v[104:105], v[196:197] op_sel:[0,0] op_sel_hi:[1,0]
    v_pk_mul_f32 v[170:171], v[106:107], v[196:197] op_sel:[0,0] op_sel_hi:[1,0]
    v_pk_mul_f32 v[172:173], v[108:109], v[196:197] op_sel:[0,0] op_sel_hi:[1,0]
    v_pk_mul_f32 v[174:175], v[110:111], v[196:197] op_sel:[0,0] op_sel_hi:[1,0]
    v_exp_f32 v168, v168
    v_exp_f32 v169, v169
    v_exp_f32 v170, v170
    v_exp_f32 v171, v171
    v_exp_f32 v172, v172
    v_exp_f32 v173, v173
    v_exp_f32 v174, v174
    v_exp_f32 v175, v175
    v_pk_fma_f32 v[168:169], v[168:169], v[198:199], v[198:199] op_sel:[0,0,0] op_sel_hi:[1,0,0]
    v_pk_fma_f32 v[170:171], v[170:171], v[198:199], v[198:199] op_sel:[0,0,0] op_sel_hi:[1,0,0]
    v_pk_fma_f32 v[172:173], v[172:173], v[198:199], v[198:199] op_sel:[0,0,0] op_sel_hi:[1,0,0]
    v_pk_fma_f32 v[174:175], v[174:175], v[198:199], v[198:199] op_sel:[0,0,0] op_sel_hi:[1,0,0]
    v_rcp_f32 v168, v168
    v_rcp_f32 v169, v169
    v_rcp_f32 v170, v170
    v_rcp_f32 v171, v171
    v_rcp_f32 v172, v172
    v_rcp_f32 v173, v173
    v_rcp_f32 v174, v174
    v_rcp_f32 v175, v175
    v_pk_mul_f32 v[168:169], v[168:169], v[104:105] op_sel:[0,0] op_sel_hi:[1,1]
    v_pk_mul_f32 v[170:171], v[170:171], v[106:107] op_sel:[0,0] op_sel_hi:[1,1]
    v_pk_mul_f32 v[172:173], v[172:173], v[108:109] op_sel:[0,0] op_sel_hi:[1,1]
    v_pk_mul_f32 v[174:175], v[174:175], v[110:111] op_sel:[0,0] op_sel_hi:[1,1]
    v_cvt_pk_bf16_f32 v24, v168, v169
    v_cvt_pk_bf16_f32 v25, v170, v171
    v_cvt_pk_bf16_f32 v26, v172, v173
    v_cvt_pk_bf16_f32 v27, v174, v175
    buffer_store_dwordx4 v[24:27], v10, s[28:31], s72 offen sc1
    s_waitcnt lgkmcnt(0)
    s_barrier
    v_pk_fma_f32 v[128:129], v[208:209], v[160:161], v[128:129] op_sel:[0,1,0] op_sel_hi:[1,1,1]
    v_pk_fma_f32 v[130:131], v[210:211], v[160:161], v[130:131] op_sel:[0,1,0] op_sel_hi:[1,1,1]
    v_pk_fma_f32 v[132:133], v[212:213], v[160:161], v[132:133] op_sel:[0,1,0] op_sel_hi:[1,1,1]
    v_pk_fma_f32 v[134:135], v[214:215], v[160:161], v[134:135] op_sel:[0,1,0] op_sel_hi:[1,1,1]
    v_pk_mul_f32 v[200:201], v[128:129], v[196:197] op_sel:[0,1] op_sel_hi:[1,1]
    v_pk_mul_f32 v[202:203], v[130:131], v[196:197] op_sel:[0,1] op_sel_hi:[1,1]
    v_pk_mul_f32 v[204:205], v[132:133], v[196:197] op_sel:[0,1] op_sel_hi:[1,1]
    v_pk_mul_f32 v[206:207], v[134:135], v[196:197] op_sel:[0,1] op_sel_hi:[1,1]
    v_exp_f32 v200, v200
    v_exp_f32 v201, v201
    v_exp_f32 v202, v202
    v_exp_f32 v203, v203
    v_exp_f32 v204, v204
    v_exp_f32 v205, v205
    v_exp_f32 v206, v206
    v_exp_f32 v207, v207
    v_pk_fma_f32 v[200:201], v[200:201], v[198:199], v[198:199] op_sel:[0,1,1] op_sel_hi:[1,1,1]
    v_pk_fma_f32 v[202:203], v[202:203], v[198:199], v[198:199] op_sel:[0,1,1] op_sel_hi:[1,1,1]
    v_pk_fma_f32 v[204:205], v[204:205], v[198:199], v[198:199] op_sel:[0,1,1] op_sel_hi:[1,1,1]
    v_pk_fma_f32 v[206:207], v[206:207], v[198:199], v[198:199] op_sel:[0,1,1] op_sel_hi:[1,1,1]
    v_rcp_f32 v200, v200
    v_rcp_f32 v201, v201
    v_rcp_f32 v202, v202
    v_rcp_f32 v203, v203
    v_rcp_f32 v204, v204
    v_rcp_f32 v205, v205
    v_rcp_f32 v206, v206
    v_rcp_f32 v207, v207
    v_pk_mul_f32 v[200:201], v[200:201], v[128:129] op_sel:[0,0] op_sel_hi:[1,1]
    v_pk_mul_f32 v[202:203], v[202:203], v[130:131] op_sel:[0,0] op_sel_hi:[1,1]
    v_pk_mul_f32 v[204:205], v[204:205], v[132:133] op_sel:[0,0] op_sel_hi:[1,1]
    v_pk_mul_f32 v[206:207], v[206:207], v[134:135] op_sel:[0,0] op_sel_hi:[1,1]
    v_cvt_pk_bf16_f32 v36, v200, v201
    v_cvt_pk_bf16_f32 v37, v202, v203
    v_cvt_pk_bf16_f32 v38, v204, v205
    v_cvt_pk_bf16_f32 v39, v206, v207
    buffer_store_dwordx4 v[36:39], v10, s[28:31], s75 offen sc1
    v_pk_fma_f32 v[112:113], v[216:217], v[160:161], v[112:113] op_sel:[0,0,0] op_sel_hi:[1,0,1]
    v_pk_fma_f32 v[114:115], v[218:219], v[160:161], v[114:115] op_sel:[0,0,0] op_sel_hi:[1,0,1]
    v_pk_fma_f32 v[116:117], v[220:221], v[160:161], v[116:117] op_sel:[0,0,0] op_sel_hi:[1,0,1]
    v_pk_fma_f32 v[118:119], v[222:223], v[160:161], v[118:119] op_sel:[0,0,0] op_sel_hi:[1,0,1]
    v_pk_mul_f32 v[168:169], v[112:113], v[196:197] op_sel:[0,0] op_sel_hi:[1,0]
    v_pk_mul_f32 v[170:171], v[114:115], v[196:197] op_sel:[0,0] op_sel_hi:[1,0]
    v_pk_mul_f32 v[172:173], v[116:117], v[196:197] op_sel:[0,0] op_sel_hi:[1,0]
    v_pk_mul_f32 v[174:175], v[118:119], v[196:197] op_sel:[0,0] op_sel_hi:[1,0]
    v_exp_f32 v168, v168
    v_exp_f32 v169, v169
    v_exp_f32 v170, v170
    v_exp_f32 v171, v171
    v_exp_f32 v172, v172
    v_exp_f32 v173, v173
    v_exp_f32 v174, v174
    v_exp_f32 v175, v175
    v_pk_fma_f32 v[168:169], v[168:169], v[198:199], v[198:199] op_sel:[0,0,0] op_sel_hi:[1,0,0]
    v_pk_fma_f32 v[170:171], v[170:171], v[198:199], v[198:199] op_sel:[0,0,0] op_sel_hi:[1,0,0]
    v_pk_fma_f32 v[172:173], v[172:173], v[198:199], v[198:199] op_sel:[0,0,0] op_sel_hi:[1,0,0]
    v_pk_fma_f32 v[174:175], v[174:175], v[198:199], v[198:199] op_sel:[0,0,0] op_sel_hi:[1,0,0]
    v_rcp_f32 v168, v168
    v_rcp_f32 v169, v169
    v_rcp_f32 v170, v170
    v_rcp_f32 v171, v171
    v_rcp_f32 v172, v172
    v_rcp_f32 v173, v173
    v_rcp_f32 v174, v174
    v_rcp_f32 v175, v175
    v_pk_mul_f32 v[168:169], v[168:169], v[112:113] op_sel:[0,0] op_sel_hi:[1,1]
    v_pk_mul_f32 v[170:171], v[170:171], v[114:115] op_sel:[0,0] op_sel_hi:[1,1]
    v_pk_mul_f32 v[172:173], v[172:173], v[116:117] op_sel:[0,0] op_sel_hi:[1,1]
    v_pk_mul_f32 v[174:175], v[174:175], v[118:119] op_sel:[0,0] op_sel_hi:[1,1]
    v_cvt_pk_bf16_f32 v28, v168, v169
    v_cvt_pk_bf16_f32 v29, v170, v171
    v_cvt_pk_bf16_f32 v30, v172, v173
    v_cvt_pk_bf16_f32 v31, v174, v175
    buffer_store_dwordx4 v[28:31], v10, s[28:31], s73 offen sc1
    v_pk_fma_f32 v[136:137], v[216:217], v[160:161], v[136:137] op_sel:[0,1,0] op_sel_hi:[1,1,1]
    v_pk_fma_f32 v[138:139], v[218:219], v[160:161], v[138:139] op_sel:[0,1,0] op_sel_hi:[1,1,1]
    v_pk_fma_f32 v[140:141], v[220:221], v[160:161], v[140:141] op_sel:[0,1,0] op_sel_hi:[1,1,1]
    v_pk_fma_f32 v[142:143], v[222:223], v[160:161], v[142:143] op_sel:[0,1,0] op_sel_hi:[1,1,1]
    v_pk_mul_f32 v[200:201], v[136:137], v[196:197] op_sel:[0,1] op_sel_hi:[1,1]
    v_pk_mul_f32 v[202:203], v[138:139], v[196:197] op_sel:[0,1] op_sel_hi:[1,1]
    v_pk_mul_f32 v[204:205], v[140:141], v[196:197] op_sel:[0,1] op_sel_hi:[1,1]
    v_pk_mul_f32 v[206:207], v[142:143], v[196:197] op_sel:[0,1] op_sel_hi:[1,1]
    v_exp_f32 v200, v200
    v_exp_f32 v201, v201
    v_exp_f32 v202, v202
    v_exp_f32 v203, v203
    v_exp_f32 v204, v204
    v_exp_f32 v205, v205
    v_exp_f32 v206, v206
    v_exp_f32 v207, v207
    v_pk_fma_f32 v[200:201], v[200:201], v[198:199], v[198:199] op_sel:[0,1,1] op_sel_hi:[1,1,1]
    v_pk_fma_f32 v[202:203], v[202:203], v[198:199], v[198:199] op_sel:[0,1,1] op_sel_hi:[1,1,1]
    v_pk_fma_f32 v[204:205], v[204:205], v[198:199], v[198:199] op_sel:[0,1,1] op_sel_hi:[1,1,1]
    v_pk_fma_f32 v[206:207], v[206:207], v[198:199], v[198:199] op_sel:[0,1,1] op_sel_hi:[1,1,1]
    v_rcp_f32 v200, v200
    v_rcp_f32 v201, v201
    v_rcp_f32 v202, v202
    v_rcp_f32 v203, v203
    v_rcp_f32 v204, v204
    v_rcp_f32 v205, v205
    v_rcp_f32 v206, v206
    v_rcp_f32 v207, v207
    v_pk_mul_f32 v[200:201], v[200:201], v[136:137] op_sel:[0,0] op_sel_hi:[1,1]
    v_pk_mul_f32 v[202:203], v[202:203], v[138:139] op_sel:[0,0] op_sel_hi:[1,1]
    v_pk_mul_f32 v[204:205], v[204:205], v[140:141] op_sel:[0,0] op_sel_hi:[1,1]
    v_pk_mul_f32 v[206:207], v[206:207], v[142:143] op_sel:[0,0] op_sel_hi:[1,1]
    v_cvt_pk_bf16_f32 v40, v200, v201
    v_cvt_pk_bf16_f32 v41, v202, v203
    v_cvt_pk_bf16_f32 v42, v204, v205
    v_cvt_pk_bf16_f32 v43, v206, v207
    buffer_store_dwordx4 v[40:43], v10, s[28:31], s76 offen sc1
    v_pk_fma_f32 v[120:121], v[224:225], v[160:161], v[120:121] op_sel:[0,0,0] op_sel_hi:[1,0,1]
    v_pk_fma_f32 v[122:123], v[226:227], v[160:161], v[122:123] op_sel:[0,0,0] op_sel_hi:[1,0,1]
    v_pk_fma_f32 v[124:125], v[228:229], v[160:161], v[124:125] op_sel:[0,0,0] op_sel_hi:[1,0,1]
    v_pk_fma_f32 v[126:127], v[230:231], v[160:161], v[126:127] op_sel:[0,0,0] op_sel_hi:[1,0,1]
    v_pk_mul_f32 v[168:169], v[120:121], v[196:197] op_sel:[0,0] op_sel_hi:[1,0]
    v_pk_mul_f32 v[170:171], v[122:123], v[196:197] op_sel:[0,0] op_sel_hi:[1,0]
    v_pk_mul_f32 v[172:173], v[124:125], v[196:197] op_sel:[0,0] op_sel_hi:[1,0]
    v_pk_mul_f32 v[174:175], v[126:127], v[196:197] op_sel:[0,0] op_sel_hi:[1,0]
    v_exp_f32 v168, v168
    v_exp_f32 v169, v169
    v_exp_f32 v170, v170
    v_exp_f32 v171, v171
    v_exp_f32 v172, v172
    v_exp_f32 v173, v173
    v_exp_f32 v174, v174
    v_exp_f32 v175, v175
    v_pk_fma_f32 v[168:169], v[168:169], v[198:199], v[198:199] op_sel:[0,0,0] op_sel_hi:[1,0,0]
    v_pk_fma_f32 v[170:171], v[170:171], v[198:199], v[198:199] op_sel:[0,0,0] op_sel_hi:[1,0,0]
    v_pk_fma_f32 v[172:173], v[172:173], v[198:199], v[198:199] op_sel:[0,0,0] op_sel_hi:[1,0,0]
    v_pk_fma_f32 v[174:175], v[174:175], v[198:199], v[198:199] op_sel:[0,0,0] op_sel_hi:[1,0,0]
    v_rcp_f32 v168, v168
    v_rcp_f32 v169, v169
    v_rcp_f32 v170, v170
    v_rcp_f32 v171, v171
    v_rcp_f32 v172, v172
    v_rcp_f32 v173, v173
    v_rcp_f32 v174, v174
    v_rcp_f32 v175, v175
    v_pk_mul_f32 v[168:169], v[168:169], v[120:121] op_sel:[0,0] op_sel_hi:[1,1]
    v_pk_mul_f32 v[170:171], v[170:171], v[122:123] op_sel:[0,0] op_sel_hi:[1,1]
    v_pk_mul_f32 v[172:173], v[172:173], v[124:125] op_sel:[0,0] op_sel_hi:[1,1]
    v_pk_mul_f32 v[174:175], v[174:175], v[126:127] op_sel:[0,0] op_sel_hi:[1,1]
    v_cvt_pk_bf16_f32 v32, v168, v169
    v_cvt_pk_bf16_f32 v33, v170, v171
    v_cvt_pk_bf16_f32 v34, v172, v173
    v_cvt_pk_bf16_f32 v35, v174, v175
    buffer_store_dwordx4 v[32:35], v10, s[28:31], s74 offen sc1
    v_pk_fma_f32 v[144:145], v[224:225], v[160:161], v[144:145] op_sel:[0,1,0] op_sel_hi:[1,1,1]
    v_pk_fma_f32 v[146:147], v[226:227], v[160:161], v[146:147] op_sel:[0,1,0] op_sel_hi:[1,1,1]
    v_pk_fma_f32 v[148:149], v[228:229], v[160:161], v[148:149] op_sel:[0,1,0] op_sel_hi:[1,1,1]
    v_pk_fma_f32 v[150:151], v[230:231], v[160:161], v[150:151] op_sel:[0,1,0] op_sel_hi:[1,1,1]
    v_pk_mul_f32 v[200:201], v[144:145], v[196:197] op_sel:[0,1] op_sel_hi:[1,1]
    v_pk_mul_f32 v[202:203], v[146:147], v[196:197] op_sel:[0,1] op_sel_hi:[1,1]
    v_pk_mul_f32 v[204:205], v[148:149], v[196:197] op_sel:[0,1] op_sel_hi:[1,1]
    v_pk_mul_f32 v[206:207], v[150:151], v[196:197] op_sel:[0,1] op_sel_hi:[1,1]
    v_exp_f32 v200, v200
    v_exp_f32 v201, v201
    v_exp_f32 v202, v202
    v_exp_f32 v203, v203
    v_exp_f32 v204, v204
    v_exp_f32 v205, v205
    v_exp_f32 v206, v206
    v_exp_f32 v207, v207
    v_pk_fma_f32 v[200:201], v[200:201], v[198:199], v[198:199] op_sel:[0,1,1] op_sel_hi:[1,1,1]
    v_pk_fma_f32 v[202:203], v[202:203], v[198:199], v[198:199] op_sel:[0,1,1] op_sel_hi:[1,1,1]
    v_pk_fma_f32 v[204:205], v[204:205], v[198:199], v[198:199] op_sel:[0,1,1] op_sel_hi:[1,1,1]
    v_pk_fma_f32 v[206:207], v[206:207], v[198:199], v[198:199] op_sel:[0,1,1] op_sel_hi:[1,1,1]
    v_rcp_f32 v200, v200
    v_rcp_f32 v201, v201
    v_rcp_f32 v202, v202
    v_rcp_f32 v203, v203
    v_rcp_f32 v204, v204
    v_rcp_f32 v205, v205
    v_rcp_f32 v206, v206
    v_rcp_f32 v207, v207
    v_pk_mul_f32 v[200:201], v[200:201], v[144:145] op_sel:[0,0] op_sel_hi:[1,1]
    v_pk_mul_f32 v[202:203], v[202:203], v[146:147] op_sel:[0,0] op_sel_hi:[1,1]
    v_pk_mul_f32 v[204:205], v[204:205], v[148:149] op_sel:[0,0] op_sel_hi:[1,1]
    v_pk_mul_f32 v[206:207], v[206:207], v[150:151] op_sel:[0,0] op_sel_hi:[1,1]
    v_cvt_pk_bf16_f32 v44, v200, v201
    v_cvt_pk_bf16_f32 v45, v202, v203
    v_cvt_pk_bf16_f32 v46, v204, v205
    v_cvt_pk_bf16_f32 v47, v206, v207
    buffer_store_dwordx4 v[44:47], v10, s[28:31], s77 offen sc1
    v_lshrrev_b32 v4, 2, v2
    v_lshlrev_b32 v5, 2, v3
    v_add_u32 v4, v4, v5
    v_lshrrev_b32 v5, 1, v4
    v_and_b32 v5, 3, v5
    v_lshlrev_b32 v4, 7, v4
    v_and_b32 v6, 3, v1
    v_lshlrev_b32 v6, 3, v6
    s_mul_i32 s41, s39, 81920
    v_add3_u32 v4, v4, v6, s41
    v_xor_b32 v6, 0, v5
    v_lshlrev_b32 v6, 5, v6
    v_add_u32 v168, v4, v6
    v_xor_b32 v6, 1, v5
    v_lshlrev_b32 v6, 5, v6
    v_add_u32 v169, v4, v6
    v_xor_b32 v6, 2, v5
    v_lshlrev_b32 v6, 5, v6
    v_add_u32 v170, v4, v6
    v_xor_b32 v6, 3, v5
    v_lshlrev_b32 v6, 5, v6
    v_add_u32 v171, v4, v6
    v_add_u32 v172, 0x10000, v168
    v_add_u32 v173, 0x10000, v169
    v_add_u32 v174, 0x10000, v170
    v_add_u32 v175, 0x10000, v171
    s_lshl_b32 s41, s34, 2
    s_add_u32 s42, s41, s40
    s_mul_i32 s42, s42, 43
    s_mul_i32 s43, s39, 22
    s_add_u32 s42, s42, s43
    s_lshl_b32 s42, s42, 10
    s_add_u32 s42, s42, 4194304
    v_add_u32 v176, s42, v10
    s_xor_b32 s42, s40, 1
    s_add_u32 s42, s41, s42
    s_mul_i32 s42, s42, 43
    s_add_u32 s42, s42, s43
    s_lshl_b32 s42, s42, 10
    s_add_u32 s42, s42, 4194304
    v_add_u32 v177, s42, v10
    s_sub_u32 s41, 22, s39
    s_add_u32 s42, s70, 0
    s_cmp_ge_u32 s42, s41
    s_cselect_b32 s43, s41, 0
    s_sub_u32 s42, s42, s43
    s_lshl_b32 s72, s42, 10
    s_add_u32 s42, s70, 1
    s_cmp_ge_u32 s42, s41
    s_cselect_b32 s43, s41, 0
    s_sub_u32 s42, s42, s43
    s_lshl_b32 s73, s42, 10
    s_add_u32 s42, s70, 2
    s_cmp_ge_u32 s42, s41
    s_cselect_b32 s43, s41, 0
    s_sub_u32 s42, s42, s43
    s_lshl_b32 s74, s42, 10
    s_add_u32 s42, s70, 3
    s_cmp_ge_u32 s42, s41
    s_cselect_b32 s43, s41, 0
    s_sub_u32 s42, s42, s43
    s_lshl_b32 s75, s42, 10
    s_add_u32 s42, s70, 4
    s_cmp_ge_u32 s42, s41
    s_cselect_b32 s43, s41, 0
    s_sub_u32 s42, s42, s43
    s_lshl_b32 s76, s42, 10
    s_add_u32 s42, s70, 5
    s_cmp_ge_u32 s42, s41
    s_cselect_b32 s43, s41, 0
    s_sub_u32 s42, s42, s43
    s_lshl_b32 s77, s42, 10
    s_add_u32 s42, s70, 6
    s_cmp_ge_u32 s42, s41
    s_cselect_b32 s43, s41, 0
    s_sub_u32 s42, s42, s43
    s_lshl_b32 s78, s42, 10
    s_add_u32 s42, s70, 7
    s_cmp_ge_u32 s42, s41
    s_cselect_b32 s43, s41, 0
    s_sub_u32 s42, s42, s43
    s_lshl_b32 s79, s42, 10
    s_add_u32 s42, s70, 8
    s_cmp_ge_u32 s42, s41
    s_cselect_b32 s43, s41, 0
    s_sub_u32 s42, s42, s43
    s_lshl_b32 s80, s42, 10
    s_add_u32 s42, s70, 9
    s_cmp_ge_u32 s42, s41
    s_cselect_b32 s43, s41, 0
    s_sub_u32 s42, s42, s43
    s_lshl_b32 s81, s42, 10
    s_add_u32 s42, s70, 10
    s_cmp_ge_u32 s42, s41
    s_cselect_b32 s43, s41, 0
    s_sub_u32 s42, s42, s43
    s_lshl_b32 s82, s42, 10
    s_add_u32 s42, s70, 11
    s_cmp_ge_u32 s42, s41
    s_cselect_b32 s43, s41, 0
    s_sub_u32 s42, s42, s43
    s_lshl_b32 s83, s42, 10
    s_add_u32 s42, s70, 12
    s_cmp_ge_u32 s42, s41
    s_cselect_b32 s43, s41, 0
    s_sub_u32 s42, s42, s43
    s_lshl_b32 s84, s42, 10
    s_add_u32 s42, s70, 13
    s_cmp_ge_u32 s42, s41
    s_cselect_b32 s43, s41, 0
    s_sub_u32 s42, s42, s43
    s_lshl_b32 s85, s42, 10
    s_add_u32 s42, s70, 14
    s_cmp_ge_u32 s42, s41
    s_cselect_b32 s43, s41, 0
    s_sub_u32 s42, s42, s43
    s_lshl_b32 s86, s42, 10
    s_add_u32 s42, s70, 15
    s_cmp_ge_u32 s42, s41
    s_cselect_b32 s43, s41, 0
    s_sub_u32 s42, s42, s43
    s_lshl_b32 s87, s42, 10
    s_add_u32 s42, s70, 16
    s_cmp_ge_u32 s42, s41
    s_cselect_b32 s43, s41, 0
    s_sub_u32 s42, s42, s43
    s_lshl_b32 s88, s42, 10
    s_add_u32 s42, s70, 17
    s_cmp_ge_u32 s42, s41
    s_cselect_b32 s43, s41, 0
    s_sub_u32 s42, s42, s43
    s_lshl_b32 s89, s42, 10
    s_add_u32 s42, s70, 18
    s_cmp_ge_u32 s42, s41
    s_cselect_b32 s43, s41, 0
    s_sub_u32 s42, s42, s43
    s_lshl_b32 s90, s42, 10
    s_add_u32 s42, s70, 19
    s_cmp_ge_u32 s42, s41
    s_cselect_b32 s43, s41, 0
    s_sub_u32 s42, s42, s43
    s_lshl_b32 s91, s42, 10
    s_add_u32 s42, s70, 20
    s_cmp_ge_u32 s42, s41
    s_cselect_b32 s43, s41, 0
    s_sub_u32 s42, s42, s43
    s_lshl_b32 s92, s42, 10
    s_add_u32 s42, s70, 21
    s_cmp_ge_u32 s42, s41
    s_cselect_b32 s43, s41, 0
    s_sub_u32 s42, s42, s43
    s_lshl_b32 s93, s42, 10
    s_lshl_b32 s41, s36, 12
    s_add_u32 s41, s41, 8192
    v_add_u32 v178, s41, v10
    s_xor_b32 s42, s36, 2
    s_lshl_b32 s42, s42, 12
    s_add_u32 s42, s42, 8192
    v_add_u32 v179, s42, v10
    v_lshlrev_b32 v136, 16, v16
    v_and_b32 v137, 0xffff0000, v16
    v_lshlrev_b32 v138, 16, v17
    v_and_b32 v139, 0xffff0000, v17
    v_lshlrev_b32 v140, 16, v18
    v_and_b32 v141, 0xffff0000, v18
    v_lshlrev_b32 v142, 16, v19
    v_and_b32 v143, 0xffff0000, v19
    v_lshlrev_b32 v144, 16, v20
    v_and_b32 v145, 0xffff0000, v20
    v_lshlrev_b32 v146, 16, v21
    v_and_b32 v147, 0xffff0000, v21
    v_lshlrev_b32 v148, 16, v22
    v_and_b32 v149, 0xffff0000, v22
    v_lshlrev_b32 v150, 16, v23
    v_and_b32 v151, 0xffff0000, v23
    s_waitcnt vmcnt(0)
    s_movk_i32 s41, 8192
    v_mov_b32 v5, 1
    s_mov_b64 exec, 1
    s_cmp_eq_u32 s53, 0
    s_cbranch_scc1 L_xslow_16
    buffer_store_dword v5, v11, s[28:31], s41 offen
L_xjoin_17:
    s_mov_b64 exec, -1
    s_lshl_b32 s41, s34, 7
    s_lshl_b32 s42, s39, 6
    s_add_u32 s41, s41, s42
    s_add_u32 s41, s41, 11534336
    s_cmp_eq_u32 s39, 0
    s_cselect_b32 s42, 19, 15
    v_min_u32 v6, s42, v1
    v_lshlrev_b32 v6, 2, v6
    v_add_u32 v14, s41, v6
    s_barrier
    ds_read_b64_tr_b16 v[104:105], v168 offset:0
    ds_read_b64_tr_b16 v[106:107], v168 offset:2048
    ds_read_b64_tr_b16 v[108:109], v169 offset:0
    ds_read_b64_tr_b16 v[110:111], v169 offset:2048
    ds_read_b64_tr_b16 v[112:113], v170 offset:0
    ds_read_b64_tr_b16 v[114:115], v170 offset:2048
    ds_read_b64_tr_b16 v[116:117], v171 offset:0
    ds_read_b64_tr_b16 v[118:119], v171 offset:2048
    s_mov_b32 s48, 200000
    s_movk_i32 s42, 8192
L_poll_19:
    buffer_load_dword v4, v14, s[28:31], s42 offen sc1
    s_waitcnt vmcnt(0)
    v_cmp_eq_u32 vcc, 1, v4
    s_nop 1
    s_cmp_eq_u64 vcc, -1
    s_cbranch_scc1 L_pdone_18
    s_sub_u32 s48, s48, 1
    s_cmp_eq_u32 s48, 0
    s_cbranch_scc1 L_pdone_18
    s_branch L_poll_19
L_pdone_18:
    buffer_load_dwordx4 v[24:27], v176, s[28:31], s72 offen sc1
    buffer_load_dwordx4 v[28:31], v177, s[28:31], s72 offen sc1
    buffer_load_dwordx4 v[32:35], v176, s[28:31], s73 offen sc1
    buffer_load_dwordx4 v[36:39], v177, s[28:31], s73 offen sc1
    buffer_load_dwordx4 v[40:43], v176, s[28:31], s74 offen sc1
    buffer_load_dwordx4 v[44:47], v177, s[28:31], s74 offen sc1
    buffer_load_dwordx4 v[48:51], v176, s[28:31], s75 offen sc1
    buffer_load_dwordx4 v[52:55], v177, s[28:31], s75 offen sc1
    buffer_load_dwordx4 v[56:59], v176, s[28:31], s76 offen sc1
    buffer_load_dwordx4 v[60:63], v177, s[28:31], s76 offen sc1
    s_waitcnt vmcnt(8)
    s_waitcnt lgkmcnt(4)
    v_mfma_f32_16x16x32_bf16 v[136:139], v[104:107], v[24:27], v[136:139]
    ds_read_b64_tr_b16 v[120:121], v168 offset:4096
    v_mfma_f32_16x16x32_bf16 v[152:155], v[104:107], v[28:31], 0
    ds_read_b64_tr_b16 v[122:123], v168 offset:6144
    buffer_load_dwordx4 v[64:67], v176, s[28:31], s77 offen sc1
    v_mfma_f32_16x16x32_bf16 v[140:143], v[108:111], v[24:27], v[140:143]
    ds_read_b64_tr_b16 v[124:125], v169 offset:4096
    v_mfma_f32_16x16x32_bf16 v[156:159], v[108:111], v[28:31], 0
    ds_read_b64_tr_b16 v[126:127], v169 offset:6144
    buffer_load_dwordx4 v[68:71], v177, s[28:31], s77 offen sc1
    s_waitcnt lgkmcnt(4)
    v_mfma_f32_16x16x32_bf16 v[144:147], v[112:115], v[24:27], v[144:147]
    ds_read_b64_tr_b16 v[128:129], v170 offset:4096
    v_mfma_f32_16x16x32_bf16 v[160:163], v[112:115], v[28:31], 0
    ds_read_b64_tr_b16 v[130:131], v170 offset:6144
    buffer_load_dwordx4 v[72:75], v176, s[28:31], s78 offen sc1
    v_mfma_f32_16x16x32_bf16 v[148:151], v[116:119], v[24:27], v[148:151]
    ds_read_b64_tr_b16 v[132:133], v171 offset:4096
    v_mfma_f32_16x16x32_bf16 v[164:167], v[116:119], v[28:31], 0
    ds_read_b64_tr_b16 v[134:135], v171 offset:6144
    buffer_load_dwordx4 v[76:79], v177, s[28:31], s78 offen sc1
    s_waitcnt vmcnt(10)
    s_waitcnt lgkmcnt(4)
    v_mfma_f32_16x16x32_bf16 v[136:139], v[120:123], v[32:35], v[136:139]
    ds_read_b64_tr_b16 v[104:105], v168 offset:8192
    v_mfma_f32_16x16x32_bf16 v[152:155], v[120:123], v[36:39], v[152:155]
    ds_read_b64_tr_b16 v[106:107], v168 offset:10240
    buffer_load_dwordx4 v[80:83], v176, s[28:31], s79 offen sc1
    v_mfma_f32_16x16x32_bf16 v[140:143], v[124:127], v[32:35], v[140:143]
    ds_read_b64_tr_b16 v[108:109], v169 offset:8192
    v_mfma_f32_16x16x32_bf16 v[156:159], v[124:127], v[36:39], v[156:159]
    ds_read_b64_tr_b16 v[110:111], v169 offset:10240
    buffer_load_dwordx4 v[84:87], v177, s[28:31], s79 offen sc1
    s_waitcnt lgkmcnt(4)
    v_mfma_f32_16x16x32_bf16 v[144:147], v[128:131], v[32:35], v[144:147]
    ds_read_b64_tr_b16 v[112:113], v170 offset:8192
    v_mfma_f32_16x16x32_bf16 v[160:163], v[128:131], v[36:39], v[160:163]
    ds_read_b64_tr_b16 v[114:115], v170 offset:10240
    buffer_load_dwordx4 v[88:91], v176, s[28:31], s80 offen sc1
    v_mfma_f32_16x16x32_bf16 v[148:151], v[132:135], v[32:35], v[148:151]
    ds_read_b64_tr_b16 v[116:117], v171 offset:8192
    v_mfma_f32_16x16x32_bf16 v[164:167], v[132:135], v[36:39], v[164:167]
    ds_read_b64_tr_b16 v[118:119], v171 offset:10240
    buffer_load_dwordx4 v[92:95], v177, s[28:31], s80 offen sc1
    s_waitcnt vmcnt(12)
    s_waitcnt lgkmcnt(4)
    v_mfma_f32_16x16x32_bf16 v[136:139], v[104:107], v[40:43], v[136:139]
    ds_read_b64_tr_b16 v[120:121], v168 offset:12288
    v_mfma_f32_16x16x32_bf16 v[152:155], v[104:107], v[44:47], v[152:155]
    ds_read_b64_tr_b16 v[122:123], v168 offset:14336
    buffer_load_dwordx4 v[96:99], v176, s[28:31], s81 offen sc1
    v_mfma_f32_16x16x32_bf16 v[140:143], v[108:111], v[40:43], v[140:143]
    ds_read_b64_tr_b16 v[124:125], v169 offset:12288
    v_mfma_f32_16x16x32_bf16 v[156:159], v[108:111], v[44:47], v[156:159]
    ds_read_b64_tr_b16 v[126:127], v169 offset:14336
    buffer_load_dwordx4 v[100:103], v177, s[28:31], s81 offen sc1
    s_waitcnt lgkmcnt(4)
    v_mfma_f32_16x16x32_bf16 v[144:147], v[112:115], v[40:43], v[144:147]
    ds_read_b64_tr_b16 v[128:129], v170 offset:12288
    v_mfma_f32_16x16x32_bf16 v[160:163], v[112:115], v[44:47], v[160:163]
    ds_read_b64_tr_b16 v[130:131], v170 offset:14336
    buffer_load_dwordx4 v[24:27], v176, s[28:31], s82 offen sc1
    v_mfma_f32_16x16x32_bf16 v[148:151], v[116:119], v[40:43], v[148:151]
    ds_read_b64_tr_b16 v[132:133], v171 offset:12288
    v_mfma_f32_16x16x32_bf16 v[164:167], v[116:119], v[44:47], v[164:167]
    ds_read_b64_tr_b16 v[134:135], v171 offset:14336
    buffer_load_dwordx4 v[28:31], v177, s[28:31], s82 offen sc1
    s_barrier
    s_waitcnt vmcnt(14)
    s_waitcnt lgkmcnt(4)
    v_mfma_f32_16x16x32_bf16 v[136:139], v[120:123], v[48:51], v[136:139]
    ds_read_b64_tr_b16 v[104:105], v168 offset:16384
    v_mfma_f32_16x16x32_bf16 v[152:155], v[120:123], v[52:55], v[152:155]
    ds_read_b64_tr_b16 v[106:107], v168 offset:18432
    buffer_load_dwordx4 v[32:35], v176, s[28:31], s83 offen sc1
    v_mfma_f32_16x16x32_bf16 v[140:143], v[124:127], v[48:51], v[140:143]
    ds_read_b64_tr_b16 v[108:109], v169 offset:16384
    v_mfma_f32_16x16x32_bf16 v[156:159], v[124:127], v[52:55], v[156:159]
    ds_read_b64_tr_b16 v[110:111], v169 offset:18432
    buffer_load_dwordx4 v[36:39], v177, s[28:31], s83 offen sc1
    s_waitcnt lgkmcnt(4)
    v_mfma_f32_16x16x32_bf16 v[144:147], v[128:131], v[48:51], v[144:147]
    ds_read_b64_tr_b16 v[112:113], v170 offset:16384
    v_mfma_f32_16x16x32_bf16 v[160:163], v[128:131], v[52:55], v[160:163]
    ds_read_b64_tr_b16 v[114:115], v170 offset:18432
    v_mfma_f32_16x16x32_bf16 v[148:151], v[132:135], v[48:51], v[148:151]
    ds_read_b64_tr_b16 v[116:117], v171 offset:16384
    v_mfma_f32_16x16x32_bf16 v[164:167], v[132:135], v[52:55], v[164:167]
    ds_read_b64_tr_b16 v[118:119], v171 offset:18432
    s_waitcnt vmcnt(14)
    s_waitcnt lgkmcnt(4)
    v_mfma_f32_16x16x32_bf16 v[136:139], v[104:107], v[56:59], v[136:139]
    ds_read_b64_tr_b16 v[120:121], v168 offset:20480
    v_mfma_f32_16x16x32_bf16 v[152:155], v[104:107], v[60:63], v[152:155]
    ds_read_b64_tr_b16 v[122:123], v168 offset:22528
    buffer_load_dwordx4 v[40:43], v176, s[28:31], s84 offen sc1
    v_mfma_f32_16x16x32_bf16 v[140:143], v[108:111], v[56:59], v[140:143]
    ds_read_b64_tr_b16 v[124:125], v169 offset:20480
    v_mfma_f32_16x16x32_bf16 v[156:159], v[108:111], v[60:63], v[156:159]
    ds_read_b64_tr_b16 v[126:127], v169 offset:22528
    buffer_load_dwordx4 v[44:47], v177, s[28:31], s84 offen sc1
    s_waitcnt lgkmcnt(4)
    v_mfma_f32_16x16x32_bf16 v[144:147], v[112:115], v[56:59], v[144:147]
    ds_read_b64_tr_b16 v[128:129], v170 offset:20480
    v_mfma_f32_16x16x32_bf16 v[160:163], v[112:115], v[60:63], v[160:163]
    ds_read_b64_tr_b16 v[130:131], v170 offset:22528
    v_mfma_f32_16x16x32_bf16 v[148:151], v[116:119], v[56:59], v[148:151]
    ds_read_b64_tr_b16 v[132:133], v171 offset:20480
    v_mfma_f32_16x16x32_bf16 v[164:167], v[116:119], v[60:63], v[164:167]
    ds_read_b64_tr_b16 v[134:135], v171 offset:22528
    s_waitcnt vmcnt(14)
    s_waitcnt lgkmcnt(4)
    v_mfma_f32_16x16x32_bf16 v[136:139], v[120:123], v[64:67], v[136:139]
    ds_read_b64_tr_b16 v[104:105], v168 offset:24576
    v_mfma_f32_16x16x32_bf16 v[152:155], v[120:123], v[68:71], v[152:155]
    ds_read_b64_tr_b16 v[106:107], v168 offset:26624
    buffer_load_dwordx4 v[48:51], v176, s[28:31], s85 offen sc1
    v_mfma_f32_16x16x32_bf16 v[140:143], v[124:127], v[64:67], v[140:143]
    ds_read_b64_tr_b16 v[108:109], v169 offset:24576
    v_mfma_f32_16x16x32_bf16 v[156:159], v[124:127], v[68:71], v[156:159]
    ds_read_b64_tr_b16 v[110:111], v169 offset:26624
    buffer_load_dwordx4 v[52:55], v177, s[28:31], s85 offen sc1
    s_waitcnt lgkmcnt(4)
    v_mfma_f32_16x16x32_bf16 v[144:147], v[128:131], v[64:67], v[144:147]
    ds_read_b64_tr_b16 v[112:113], v170 offset:24576
    v_mfma_f32_16x16x32_bf16 v[160:163], v[128:131], v[68:71], v[160:163]
    ds_read_b64_tr_b16 v[114:115], v170 offset:26624
    v_mfma_f32_16x16x32_bf16 v[148:151], v[132:135], v[64:67], v[148:151]
    ds_read_b64_tr_b16 v[116:117], v171 offset:24576
    v_mfma_f32_16x16x32_bf16 v[164:167], v[132:135], v[68:71], v[164:167]
    ds_read_b64_tr_b16 v[118:119], v171 offset:26624
    s_waitcnt vmcnt(14)
    s_waitcnt lgkmcnt(4)
    v_mfma_f32_16x16x32_bf16 v[136:139], v[104:107], v[72:75], v[136:139]
    ds_read_b64_tr_b16 v[120:121], v168 offset:28672
    v_mfma_f32_16x16x32_bf16 v[152:155], v[104:107], v[76:79], v[152:155]
    ds_read_b64_tr_b16 v[122:123], v168 offset:30720
    buffer_load_dwordx4 v[56:59], v176, s[28:31], s86 offen sc1
    v_mfma_f32_16x16x32_bf16 v[140:143], v[108:111], v[72:75], v[140:143]
    ds_read_b64_tr_b16 v[124:125], v169 offset:28672
    v_mfma_f32_16x16x32_bf16 v[156:159], v[108:111], v[76:79], v[156:159]
    ds_read_b64_tr_b16 v[126:127], v169 offset:30720
    buffer_load_dwordx4 v[60:63], v177, s[28:31], s86 offen sc1
    s_waitcnt lgkmcnt(4)
    v_mfma_f32_16x16x32_bf16 v[144:147], v[112:115], v[72:75], v[144:147]
    ds_read_b64_tr_b16 v[128:129], v170 offset:28672
    v_mfma_f32_16x16x32_bf16 v[160:163], v[112:115], v[76:79], v[160:163]
    ds_read_b64_tr_b16 v[130:131], v170 offset:30720
    v_mfma_f32_16x16x32_bf16 v[148:151], v[116:119], v[72:75], v[148:151]
    ds_read_b64_tr_b16 v[132:133], v171 offset:28672
    v_mfma_f32_16x16x32_bf16 v[164:167], v[116:119], v[76:79], v[164:167]
    ds_read_b64_tr_b16 v[134:135], v171 offset:30720
    s_waitcnt vmcnt(14)
    s_waitcnt lgkmcnt(4)
    v_mfma_f32_16x16x32_bf16 v[136:139], v[120:123], v[80:83], v[136:139]
    ds_read_b64_tr_b16 v[104:105], v168 offset:32768
    v_mfma_f32_16x16x32_bf16 v[152:155], v[120:123], v[84:87], v[152:155]
    ds_read_b64_tr_b16 v[106:107], v168 offset:34816
    buffer_load_dwordx4 v[64:67], v176, s[28:31], s87 offen sc1
    v_mfma_f32_16x16x32_bf16 v[140:143], v[124:127], v[80:83], v[140:143]
    ds_read_b64_tr_b16 v[108:109], v169 offset:32768
    v_mfma_f32_16x16x32_bf16 v[156:159], v[124:127], v[84:87], v[156:159]
    ds_read_b64_tr_b16 v[110:111], v169 offset:34816
    buffer_load_dwordx4 v[68:71], v177, s[28:31], s87 offen sc1
    s_waitcnt lgkmcnt(4)
    v_mfma_f32_16x16x32_bf16 v[144:147], v[128:131], v[80:83], v[144:147]
    ds_read_b64_tr_b16 v[112:113], v170 offset:32768
    v_mfma_f32_16x16x32_bf16 v[160:163], v[128:131], v[84:87], v[160:163]
    ds_read_b64_tr_b16 v[114:115], v170 offset:34816
    v_mfma_f32_16x16x32_bf16 v[148:151], v[132:135], v[80:83], v[148:151]
    ds_read_b64_tr_b16 v[116:117], v171 offset:32768
    v_mfma_f32_16x16x32_bf16 v[164:167], v[132:135], v[84:87], v[164:167]
    ds_read_b64_tr_b16 v[118:119], v171 offset:34816
    s_waitcnt vmcnt(14)
    s_waitcnt lgkmcnt(4)
    v_mfma_f32_16x16x32_bf16 v[136:139], v[104:107], v[88:91], v[136:139]
    ds_read_b64_tr_b16 v[120:121], v168 offset:36864
    v_mfma_f32_16x16x32_bf16 v[152:155], v[104:107], v[92:95], v[152:155]
    ds_read_b64_tr_b16 v[122:123], v168 offset:38912
    buffer_load_dwordx4 v[72:75], v176, s[28:31], s88 offen sc1
    v_mfma_f32_16x16x32_bf16 v[140:143], v[108:111], v[88:91], v[140:143]
    ds_read_b64_tr_b16 v[124:125], v169 offset:36864
    v_mfma_f32_16x16x32_bf16 v[156:159], v[108:111], v[92:95], v[156:159]
    ds_read_b64_tr_b16 v[126:127], v169 offset:38912
    buffer_load_dwordx4 v[76:79], v177, s[28:31], s88 offen sc1
    s_waitcnt lgkmcnt(4)
    v_mfma_f32_16x16x32_bf16 v[144:147], v[112:115], v[88:91], v[144:147]
    ds_read_b64_tr_b16 v[128:129], v170 offset:36864
    v_mfma_f32_16x16x32_bf16 v[160:163], v[112:115], v[92:95], v[160:163]
    ds_read_b64_tr_b16 v[130:131], v170 offset:38912
    v_mfma_f32_16x16x32_bf16 v[148:151], v[116:119], v[88:91], v[148:151]
    ds_read_b64_tr_b16 v[132:133], v171 offset:36864
    v_mfma_f32_16x16x32_bf16 v[164:167], v[116:119], v[92:95], v[164:167]
    ds_read_b64_tr_b16 v[134:135], v171 offset:38912
    s_waitcnt vmcnt(14)
    s_waitcnt lgkmcnt(4)
    v_mfma_f32_16x16x32_bf16 v[136:139], v[120:123], v[96:99], v[136:139]
    ds_read_b64_tr_b16 v[104:105], v168 offset:40960
    v_mfma_f32_16x16x32_bf16 v[152:155], v[120:123], v[100:103], v[152:155]
    ds_read_b64_tr_b16 v[106:107], v168 offset:43008
    buffer_load_dwordx4 v[80:83], v176, s[28:31], s89 offen sc1
    v_mfma_f32_16x16x32_bf16 v[140:143], v[124:127], v[96:99], v[140:143]
    ds_read_b64_tr_b16 v[108:109], v169 offset:40960
    v_mfma_f32_16x16x32_bf16 v[156:159], v[124:127], v[100:103], v[156:159]
    ds_read_b64_tr_b16 v[110:111], v169 offset:43008
    buffer_load_dwordx4 v[84:87], v177, s[28:31], s89 offen sc1
    s_waitcnt lgkmcnt(4)
    v_mfma_f32_16x16x32_bf16 v[144:147], v[128:131], v[96:99], v[144:147]
    ds_read_b64_tr_b16 v[112:113], v170 offset:40960
    v_mfma_f32_16x16x32_bf16 v[160:163], v[128:131], v[100:103], v[160:163]
    ds_read_b64_tr_b16 v[114:115], v170 offset:43008
    v_mfma_f32_16x16x32_bf16 v[148:151], v[132:135], v[96:99], v[148:151]
    ds_read_b64_tr_b16 v[116:117], v171 offset:40960
    v_mfma_f32_16x16x32_bf16 v[164:167], v[132:135], v[100:103], v[164:167]
    ds_read_b64_tr_b16 v[118:119], v171 offset:43008
    s_waitcnt vmcnt(14)
    s_waitcnt lgkmcnt(4)
    v_mfma_f32_16x16x32_bf16 v[136:139], v[104:107], v[24:27], v[136:139]
    ds_read_b64_tr_b16 v[120:121], v168 offset:45056
    v_mfma_f32_16x16x32_bf16 v[152:155], v[104:107], v[28:31], v[152:155]
    ds_read_b64_tr_b16 v[122:123], v168 offset:47104
    buffer_load_dwordx4 v[88:91], v176, s[28:31], s90 offen sc1
    v_mfma_f32_16x16x32_bf16 v[140:143], v[108:111], v[24:27], v[140:143]
    ds_read_b64_tr_b16 v[124:125], v169 offset:45056
    v_mfma_f32_16x16x32_bf16 v[156:159], v[108:111], v[28:31], v[156:159]
    ds_read_b64_tr_b16 v[126:127], v169 offset:47104
    buffer_load_dwordx4 v[92:95], v177, s[28:31], s90 offen sc1
    s_waitcnt lgkmcnt(4)
    v_mfma_f32_16x16x32_bf16 v[144:147], v[112:115], v[24:27], v[144:147]
    ds_read_b64_tr_b16 v[128:129], v170 offset:45056
    v_mfma_f32_16x16x32_bf16 v[160:163], v[112:115], v[28:31], v[160:163]
    ds_read_b64_tr_b16 v[130:131], v170 offset:47104
    v_mfma_f32_16x16x32_bf16 v[148:151], v[116:119], v[24:27], v[148:151]
    ds_read_b64_tr_b16 v[132:133], v171 offset:45056
    v_mfma_f32_16x16x32_bf16 v[164:167], v[116:119], v[28:31], v[164:167]
    ds_read_b64_tr_b16 v[134:135], v171 offset:47104
    s_waitcnt vmcnt(14)
    s_waitcnt lgkmcnt(4)
    v_mfma_f32_16x16x32_bf16 v[136:139], v[120:123], v[32:35], v[136:139]
    ds_read_b64_tr_b16 v[104:105], v168 offset:49152
    v_mfma_f32_16x16x32_bf16 v[152:155], v[120:123], v[36:39], v[152:155]
    ds_read_b64_tr_b16 v[106:107], v168 offset:51200
    buffer_load_dwordx4 v[96:99], v176, s[28:31], s91 offen sc1
    v_mfma_f32_16x16x32_bf16 v[140:143], v[124:127], v[32:35], v[140:143]
    ds_read_b64_tr_b16 v[108:109], v169 offset:49152
    v_mfma_f32_16x16x32_bf16 v[156:159], v[124:127], v[36:39], v[156:159]
    ds_read_b64_tr_b16 v[110:111], v169 offset:51200
    buffer_load_dwordx4 v[100:103], v177, s[28:31], s91 offen sc1
    s_waitcnt lgkmcnt(4)
    v_mfma_f32_16x16x32_bf16 v[144:147], v[128:131], v[32:35], v[144:147]
    ds_read_b64_tr_b16 v[112:113], v170 offset:49152
    v_mfma_f32_16x16x32_bf16 v[160:163], v[128:131], v[36:39], v[160:163]
    ds_read_b64_tr_b16 v[114:115], v170 offset:51200
    v_mfma_f32_16x16x32_bf16 v[148:151], v[132:135], v[32:35], v[148:151]
    ds_read_b64_tr_b16 v[116:117], v171 offset:49152
    v_mfma_f32_16x16x32_bf16 v[164:167], v[132:135], v[36:39], v[164:167]
    ds_read_b64_tr_b16 v[118:119], v171 offset:51200
    s_waitcnt vmcnt(14)
    s_waitcnt lgkmcnt(4)
    v_mfma_f32_16x16x32_bf16 v[136:139], v[104:107], v[40:43], v[136:139]
    ds_read_b64_tr_b16 v[120:121], v168 offset:53248
    v_mfma_f32_16x16x32_bf16 v[152:155], v[104:107], v[44:47], v[152:155]
    ds_read_b64_tr_b16 v[122:123], v168 offset:55296
    buffer_load_dwordx4 v[24:27], v176, s[28:31], s92 offen sc1
    v_mfma_f32_16x16x32_bf16 v[140:143], v[108:111], v[40:43], v[140:143]
    ds_read_b64_tr_b16 v[124:125], v169 offset:53248
    v_mfma_f32_16x16x32_bf16 v[156:159], v[108:111], v[44:47], v[156:159]
    ds_read_b64_tr_b16 v[126:127], v169 offset:55296
    buffer_load_dwordx4 v[28:31], v177, s[28:31], s92 offen sc1
    s_waitcnt lgkmcnt(4)
    v_mfma_f32_16x16x32_bf16 v[144:147], v[112:115], v[40:43], v[144:147]
    ds_read_b64_tr_b16 v[128:129], v170 offset:53248
    v_mfma_f32_16x16x32_bf16 v[160:163], v[112:115], v[44:47], v[160:163]
    ds_read_b64_tr_b16 v[130:131], v170 offset:55296
    v_mfma_f32_16x16x32_bf16 v[148:151], v[116:119], v[40:43], v[148:151]
    ds_read_b64_tr_b16 v[132:133], v171 offset:53248
    v_mfma_f32_16x16x32_bf16 v[164:167], v[116:119], v[44:47], v[164:167]
    ds_read_b64_tr_b16 v[134:135], v171 offset:55296
    s_waitcnt vmcnt(14)
    s_waitcnt lgkmcnt(4)
    v_mfma_f32_16x16x32_bf16 v[136:139], v[120:123], v[48:51], v[136:139]
    ds_read_b64_tr_b16 v[104:105], v168 offset:57344
    v_mfma_f32_16x16x32_bf16 v[152:155], v[120:123], v[52:55], v[152:155]
    ds_read_b64_tr_b16 v[106:107], v168 offset:59392
    buffer_load_dwordx4 v[32:35], v176, s[28:31], s93 offen sc1
    v_mfma_f32_16x16x32_bf16 v[140:143], v[124:127], v[48:51], v[140:143]
    ds_read_b64_tr_b16 v[108:109], v169 offset:57344
    v_mfma_f32_16x16x32_bf16 v[156:159], v[124:127], v[52:55], v[156:159]
    ds_read_b64_tr_b16 v[110:111], v169 offset:59392
    buffer_load_dwordx4 v[36:39], v177, s[28:31], s93 offen sc1
    s_waitcnt lgkmcnt(4)
    v_mfma_f32_16x16x32_bf16 v[144:147], v[128:131], v[48:51], v[144:147]
    ds_read_b64_tr_b16 v[112:113], v170 offset:57344
    v_mfma_f32_16x16x32_bf16 v[160:163], v[128:131], v[52:55], v[160:163]
    ds_read_b64_tr_b16 v[114:115], v170 offset:59392
    v_mfma_f32_16x16x32_bf16 v[148:151], v[132:135], v[48:51], v[148:151]
    ds_read_b64_tr_b16 v[116:117], v171 offset:57344
    v_mfma_f32_16x16x32_bf16 v[164:167], v[132:135], v[52:55], v[164:167]
    ds_read_b64_tr_b16 v[118:119], v171 offset:59392
    s_waitcnt vmcnt(14)
    s_waitcnt lgkmcnt(4)
    v_mfma_f32_16x16x32_bf16 v[136:139], v[104:107], v[56:59], v[136:139]
    ds_read_b64_tr_b16 v[120:121], v168 offset:61440
    v_mfma_f32_16x16x32_bf16 v[152:155], v[104:107], v[60:63], v[152:155]
    ds_read_b64_tr_b16 v[122:123], v168 offset:63488
    v_mfma_f32_16x16x32_bf16 v[140:143], v[108:111], v[56:59], v[140:143]
    ds_read_b64_tr_b16 v[124:125], v169 offset:61440
    v_mfma_f32_16x16x32_bf16 v[156:159], v[108:111], v[60:63], v[156:159]
    ds_read_b64_tr_b16 v[126:127], v169 offset:63488
    s_waitcnt lgkmcnt(4)
    v_mfma_f32_16x16x32_bf16 v[144:147], v[112:115], v[56:59], v[144:147]
    ds_read_b64_tr_b16 v[128:129], v170 offset:61440
    v_mfma_f32_16x16x32_bf16 v[160:163], v[112:115], v[60:63], v[160:163]
    ds_read_b64_tr_b16 v[130:131], v170 offset:63488
    v_mfma_f32_16x16x32_bf16 v[148:151], v[116:119], v[56:59], v[148:151]
    ds_read_b64_tr_b16 v[132:133], v171 offset:61440
    v_mfma_f32_16x16x32_bf16 v[164:167], v[116:119], v[60:63], v[164:167]
    ds_read_b64_tr_b16 v[134:135], v171 offset:63488
    s_waitcnt vmcnt(12)
    s_waitcnt lgkmcnt(4)
    v_mfma_f32_16x16x32_bf16 v[136:139], v[120:123], v[64:67], v[136:139]
    ds_read_b64_tr_b16 v[104:105], v172 offset:0
    v_mfma_f32_16x16x32_bf16 v[152:155], v[120:123], v[68:71], v[152:155]
    ds_read_b64_tr_b16 v[106:107], v172 offset:2048
    v_mfma_f32_16x16x32_bf16 v[140:143], v[124:127], v[64:67], v[140:143]
    ds_read_b64_tr_b16 v[108:109], v173 offset:0
    v_mfma_f32_16x16x32_bf16 v[156:159], v[124:127], v[68:71], v[156:159]
    ds_read_b64_tr_b16 v[110:111], v173 offset:2048
    s_waitcnt lgkmcnt(4)
    v_mfma_f32_16x16x32_bf16 v[144:147], v[128:131], v[64:67], v[144:147]
    ds_read_b64_tr_b16 v[112:113], v174 offset:0
    v_mfma_f32_16x16x32_bf16 v[160:163], v[128:131], v[68:71], v[160:163]
    ds_read_b64_tr_b16 v[114:115], v174 offset:2048
    v_mfma_f32_16x16x32_bf16 v[148:151], v[132:135], v[64:67], v[148:151]
    ds_read_b64_tr_b16 v[116:117], v175 offset:0
    v_mfma_f32_16x16x32_bf16 v[164:167], v[132:135], v[68:71], v[164:167]
    ds_read_b64_tr_b16 v[118:119], v175 offset:2048
    s_waitcnt vmcnt(10)
    s_waitcnt lgkmcnt(4)
    v_mfma_f32_16x16x32_bf16 v[136:139], v[104:107], v[72:75], v[136:139]
    ds_read_b64_tr_b16 v[120:121], v172 offset:4096
    v_mfma_f32_16x16x32_bf16 v[152:155], v[104:107], v[76:79], v[152:155]
    ds_read_b64_tr_b16 v[122:123], v172 offset:6144
    v_mfma_f32_16x16x32_bf16 v[140:143], v[108:111], v[72:75], v[140:143]
    ds_read_b64_tr_b16 v[124:125], v173 offset:4096
    v_mfma_f32_16x16x32_bf16 v[156:159], v[108:111], v[76:79], v[156:159]
    ds_read_b64_tr_b16 v[126:127], v173 offset:6144
    s_waitcnt lgkmcnt(4)
    v_mfma_f32_16x16x32_bf16 v[144:147], v[112:115], v[72:75], v[144:147]
    ds_read_b64_tr_b16 v[128:129], v174 offset:4096
    v_mfma_f32_16x16x32_bf16 v[160:163], v[112:115], v[76:79], v[160:163]
    ds_read_b64_tr_b16 v[130:131], v174 offset:6144
    v_mfma_f32_16x16x32_bf16 v[148:151], v[116:119], v[72:75], v[148:151]
    ds_read_b64_tr_b16 v[132:133], v175 offset:4096
    v_mfma_f32_16x16x32_bf16 v[164:167], v[116:119], v[76:79], v[164:167]
    ds_read_b64_tr_b16 v[134:135], v175 offset:6144
    s_waitcnt vmcnt(8)
    s_waitcnt lgkmcnt(4)
    v_mfma_f32_16x16x32_bf16 v[136:139], v[120:123], v[80:83], v[136:139]
    ds_read_b64_tr_b16 v[104:105], v172 offset:8192
    v_mfma_f32_16x16x32_bf16 v[152:155], v[120:123], v[84:87], v[152:155]
    ds_read_b64_tr_b16 v[106:107], v172 offset:10240
    v_mfma_f32_16x16x32_bf16 v[140:143], v[124:127], v[80:83], v[140:143]
    ds_read_b64_tr_b16 v[108:109], v173 offset:8192
    v_mfma_f32_16x16x32_bf16 v[156:159], v[124:127], v[84:87], v[156:159]
    ds_read_b64_tr_b16 v[110:111], v173 offset:10240
    s_waitcnt lgkmcnt(4)
    v_mfma_f32_16x16x32_bf16 v[144:147], v[128:131], v[80:83], v[144:147]
    ds_read_b64_tr_b16 v[112:113], v174 offset:8192
    v_mfma_f32_16x16x32_bf16 v[160:163], v[128:131], v[84:87], v[160:163]
    ds_read_b64_tr_b16 v[114:115], v174 offset:10240
    v_mfma_f32_16x16x32_bf16 v[148:151], v[132:135], v[80:83], v[148:151]
    ds_read_b64_tr_b16 v[116:117], v175 offset:8192
    v_mfma_f32_16x16x32_bf16 v[164:167], v[132:135], v[84:87], v[164:167]
    ds_read_b64_tr_b16 v[118:119], v175 offset:10240
    s_barrier
    s_waitcnt vmcnt(6)
    s_waitcnt lgkmcnt(4)
    v_mfma_f32_16x16x32_bf16 v[136:139], v[104:107], v[88:91], v[136:139]
    ds_read_b64_tr_b16 v[120:121], v172 offset:12288
    v_mfma_f32_16x16x32_bf16 v[152:155], v[104:107], v[92:95], v[152:155]
    ds_read_b64_tr_b16 v[122:123], v172 offset:14336
    v_mfma_f32_16x16x32_bf16 v[140:143], v[108:111], v[88:91], v[140:143]
    ds_read_b64_tr_b16 v[124:125], v173 offset:12288
    v_mfma_f32_16x16x32_bf16 v[156:159], v[108:111], v[92:95], v[156:159]
    ds_read_b64_tr_b16 v[126:127], v173 offset:14336
    s_waitcnt lgkmcnt(4)
    v_mfma_f32_16x16x32_bf16 v[144:147], v[112:115], v[88:91], v[144:147]
    ds_read_b64_tr_b16 v[128:129], v174 offset:12288
    v_mfma_f32_16x16x32_bf16 v[160:163], v[112:115], v[92:95], v[160:163]
    ds_read_b64_tr_b16 v[130:131], v174 offset:14336
    v_mfma_f32_16x16x32_bf16 v[148:151], v[116:119], v[88:91], v[148:151]
    ds_read_b64_tr_b16 v[132:133], v175 offset:12288
    v_mfma_f32_16x16x32_bf16 v[164:167], v[116:119], v[92:95], v[164:167]
    ds_read_b64_tr_b16 v[134:135], v175 offset:14336
    s_waitcnt vmcnt(4)
    s_waitcnt lgkmcnt(4)
    v_mfma_f32_16x16x32_bf16 v[136:139], v[120:123], v[96:99], v[136:139]
    ds_read_b64_tr_b16 v[104:105], v168 offset:0
    v_mfma_f32_16x16x32_bf16 v[152:155], v[120:123], v[100:103], v[152:155]
    ds_read_b64_tr_b16 v[106:107], v168 offset:2048
    v_mfma_f32_16x16x32_bf16 v[140:143], v[124:127], v[96:99], v[140:143]
    ds_read_b64_tr_b16 v[108:109], v169 offset:0
    v_mfma_f32_16x16x32_bf16 v[156:159], v[124:127], v[100:103], v[156:159]
    ds_read_b64_tr_b16 v[110:111], v169 offset:2048
    s_waitcnt lgkmcnt(4)
    v_mfma_f32_16x16x32_bf16 v[144:147], v[128:131], v[96:99], v[144:147]
    ds_read_b64_tr_b16 v[112:113], v170 offset:0
    v_mfma_f32_16x16x32_bf16 v[160:163], v[128:131], v[100:103], v[160:163]
    ds_read_b64_tr_b16 v[114:115], v170 offset:2048
    v_mfma_f32_16x16x32_bf16 v[148:151], v[132:135], v[96:99], v[148:151]
    ds_read_b64_tr_b16 v[116:117], v171 offset:0
    v_mfma_f32_16x16x32_bf16 v[164:167], v[132:135], v[100:103], v[164:167]
    ds_read_b64_tr_b16 v[118:119], v171 offset:2048
    s_waitcnt vmcnt(2)
    s_waitcnt lgkmcnt(4)
    v_mfma_f32_16x16x32_bf16 v[136:139], v[104:107], v[24:27], v[136:139]
    ds_read_b64_tr_b16 v[120:121], v168 offset:4096
    v_mfma_f32_16x16x32_bf16 v[152:155], v[104:107], v[28:31], v[152:155]
    ds_read_b64_tr_b16 v[122:123], v168 offset:6144
    v_mfma_f32_16x16x32_bf16 v[140:143], v[108:111], v[24:27], v[140:143]
    ds_read_b64_tr_b16 v[124:125], v169 offset:4096
    v_mfma_f32_16x16x32_bf16 v[156:159], v[108:111], v[28:31], v[156:159]
    ds_read_b64_tr_b16 v[126:127], v169 offset:6144
    s_waitcnt lgkmcnt(4)
    v_mfma_f32_16x16x32_bf16 v[144:147], v[112:115], v[24:27], v[144:147]
    ds_read_b64_tr_b16 v[128:129], v170 offset:4096
    v_mfma_f32_16x16x32_bf16 v[160:163], v[112:115], v[28:31], v[160:163]
    ds_read_b64_tr_b16 v[130:131], v170 offset:6144
    v_mfma_f32_16x16x32_bf16 v[148:151], v[116:119], v[24:27], v[148:151]
    ds_read_b64_tr_b16 v[132:133], v171 offset:4096
    v_mfma_f32_16x16x32_bf16 v[164:167], v[116:119], v[28:31], v[164:167]
    ds_read_b64_tr_b16 v[134:135], v171 offset:6144
    s_cmp_lg_u32 s39, 0
    s_cbranch_scc1 L_p4skip_20
    s_waitcnt vmcnt(0)
    s_waitcnt lgkmcnt(4)
    v_mfma_f32_16x16x32_bf16 v[136:139], v[120:123], v[32:35], v[136:139]
    v_mfma_f32_16x16x32_bf16 v[152:155], v[120:123], v[36:39], v[152:155]
    v_mfma_f32_16x16x32_bf16 v[140:143], v[124:127], v[32:35], v[140:143]
    v_mfma_f32_16x16x32_bf16 v[156:159], v[124:127], v[36:39], v[156:159]
    s_waitcnt lgkmcnt(0)
    v_mfma_f32_16x16x32_bf16 v[144:147], v[128:131], v[32:35], v[144:147]
    v_mfma_f32_16x16x32_bf16 v[160:163], v[128:131], v[36:39], v[160:163]
    v_mfma_f32_16x16x32_bf16 v[148:151], v[132:135], v[32:35], v[148:151]
    v_mfma_f32_16x16x32_bf16 v[164:167], v[132:135], v[36:39], v[164:167]
L_p4skip_20:
    s_waitcnt vmcnt(0)
    s_waitcnt lgkmcnt(0)
    ds_write_b128 v178, v[152:155] offset:0
    ds_write_b128 v178, v[156:159] offset:1024
    s_nop 1
    ds_write_b128 v178, v[160:163] offset:2048
    s_nop 0
    ds_write_b128 v178, v[164:167] offset:3072
    s_waitcnt lgkmcnt(0)
    s_barrier
    ds_read_b128 v[152:155], v179 offset:0
    ds_read_b128 v[156:159], v179 offset:1024
    ds_read_b128 v[160:163], v179 offset:2048
    ds_read_b128 v[164:167], v179 offset:3072
    s_waitcnt lgkmcnt(3)
    v_pk_add_f32 v[136:137], v[136:137], v[152:153] op_sel:[0,0] op_sel_hi:[1,1]
    v_pk_add_f32 v[138:139], v[138:139], v[154:155] op_sel:[0,0] op_sel_hi:[1,1]
    v_cvt_pk_bf16_f32 v16, v136, v137
    v_cvt_pk_bf16_f32 v17, v138, v139
    s_waitcnt lgkmcnt(2)
    v_pk_add_f32 v[140:141], v[140:141], v[156:157] op_sel:[0,0] op_sel_hi:[1,1]
    v_pk_add_f32 v[142:143], v[142:143], v[158:159] op_sel:[0,0] op_sel_hi:[1,1]
    v_cvt_pk_bf16_f32 v18, v140, v141
    v_cvt_pk_bf16_f32 v19, v142, v143
    s_waitcnt lgkmcnt(1)
    v_pk_add_f32 v[144:145], v[144:145], v[160:161] op_sel:[0,0] op_sel_hi:[1,1]
    v_pk_add_f32 v[146:147], v[146:147], v[162:163] op_sel:[0,0] op_sel_hi:[1,1]
    v_cvt_pk_bf16_f32 v20, v144, v145
    v_cvt_pk_bf16_f32 v21, v146, v147
    s_waitcnt lgkmcnt(0)
    v_pk_add_f32 v[148:149], v[148:149], v[164:165] op_sel:[0,0] op_sel_hi:[1,1]
    v_pk_add_f32 v[150:151], v[150:151], v[166:167] op_sel:[0,0] op_sel_hi:[1,1]
    v_cvt_pk_bf16_f32 v22, v148, v149
    v_cvt_pk_bf16_f32 v23, v150, v151
    buffer_store_dwordx2 v[16:17], v15, s[24:27], 0 offen offset:0 nt
    buffer_store_dwordx2 v[18:19], v15, s[24:27], 0 offen offset:32 nt
    buffer_store_dwordx2 v[20:21], v15, s[24:27], 0 offen offset:64 nt
    buffer_store_dwordx2 v[22:23], v15, s[24:27], 0 offen offset:96 nt
L_end:
    s_endpgm
L_xslow_10:
    buffer_store_dword v5, v11, s[28:31], s41 offen sc1
    s_nop 1
    s_branch L_xjoin_11
L_xslow_14:
    buffer_store_dword v5, v11, s[28:31], s41 offen sc1
    s_nop 1
    s_branch L_xjoin_15
L_xslow_16:
    buffer_store_dword v5, v11, s[28:31], s41 offen sc1
    s_nop 1
    s_branch L_xjoin_17
L_code_end:
.section .rodata,"a"
.p2align 6
.amdhsa_kernel sequential_preLN__sliding_local_dilated__dense_activation_silu__prompt_kernel
  .amdhsa_next_free_vgpr 256
  .amdhsa_next_free_sgpr 102
  .amdhsa_accum_offset 256
  .amdhsa_group_segment_fixed_size 0
  .amdhsa_kernarg_size 72
  .amdhsa_user_sgpr_count 2
  .amdhsa_user_sgpr_kernarg_segment_ptr 1
  .amdhsa_system_sgpr_workgroup_id_x 1
  .amdhsa_float_denorm_mode_32 3
.end_amdhsa_kernel
```
